```python
import torch

def _softmax(x, axis=-1):
    return torch.softmax(x, dim=axis)

def _gelu(x):
    return torch.nn.functional.gelu(x, approximate='tanh')

def _silu(x):
    return torch.nn.functional.silu(x)

def _sigmoid(x):
    return torch.sigmoid(x)

def _layernorm(x, axis=-1, eps=1e-05):
    m = x.mean(dim=axis, keepdim=True)
    v = x.var(dim=axis, keepdim=True, unbiased=False)
    return (x - m) / torch.sqrt(v + eps)

def _scatter_add(tgt, idx, src, axis=0):
    return tgt.clone().index_add_(axis, idx, src)

def _segment_sum(src, seg, n):
    out = torch.zeros((n,) + src.shape[1:], dtype=src.dtype)
    return out.index_add_(0, seg, src)

def _pad(x, pw):
    flat = tuple((v for pair in reversed(pw) for v in pair))
    return torch.nn.functional.pad(x, flat)
kernel_name = 'adaLN_cond__ssm_conv_s4__mixer_gmlp__prompt'

def setup_inputs():

    _w = lambda a: (lambda t: t.to(torch.bfloat16) if t.is_floating_point() else t)(torch.as_tensor(a))

    def _A_setup():
        B, L, D, N = (1, 2048, 512, 128)
        A_re = -(lambda _x: torch.exp(torch.as_tensor(_x)))((lambda *s: torch.randn(*s, dtype=torch.bfloat16) * 3.2)(D, N))
        A_im = torch.pi * (lambda *s: torch.randn(*s, dtype=torch.bfloat16) * 0.2)(D, N)
        B_re = (lambda *s: torch.randn(*s, dtype=torch.bfloat16) * 0.2)(D, N)
        B_im = (lambda *s: torch.randn(*s, dtype=torch.bfloat16) * 0.2)(D, N)
        C_re = (lambda *s: torch.randn(*s, dtype=torch.bfloat16) * 0.2)(D, N)
        C_im = (lambda *s: torch.randn(*s, dtype=torch.bfloat16) * 0.2)(D, N)
        log_dt = (lambda *s: torch.randn(*s, dtype=torch.bfloat16) * 0.2)(D) * 0.5 - 4.0
        Dskip = (lambda *s: torch.randn(*s, dtype=torch.bfloat16) * 0.2)(D)
        return {'u': _w((lambda *s: torch.randn(*s, dtype=torch.bfloat16) * 0.05)(B, L, D)), 'A_re': _w(A_re), 'A_im': _w(A_im), 'B_re': _w(B_re), 'B_im': _w(B_im), 'C_re': _w(C_re), 'C_im': _w(C_im), 'log_dt': _w(log_dt), 'Dskip': _w(Dskip)}
    _A_in = _A_setup()

    def _B_setup():
        B, S, D, F = (1, 2048, 512, 1792)
        Fh = F // 2
        return {'x': _w((lambda *s: torch.randn(*s, dtype=torch.bfloat16) * 0.05)(B, S, D)), 'w_in': _w((lambda *s: torch.randn(*s, dtype=torch.bfloat16) * 0.2)(D, 2 * Fh)), 'w_sp': _w(0.01 * (lambda *s: torch.randn(*s, dtype=torch.bfloat16) * 0.2)(S, S)), 'b_sp': _w(1.0 + 0.01 * (lambda *s: torch.randn(*s, dtype=torch.bfloat16) * 0.05)(S)), 'w_out': _w((lambda *s: torch.randn(*s, dtype=torch.bfloat16) * 0.05)(Fh, D))}
    _B_in = _B_setup()
    return {'A_u': _A_in['u'], 'A_A_re': _A_in['A_re'], 'A_A_im': _A_in['A_im'], 'A_B_re': _A_in['B_re'], 'A_B_im': _A_in['B_im'], 'A_C_re': _A_in['C_re'], 'A_C_im': _A_in['C_im'], 'A_log_dt': _A_in['log_dt'], 'A_Dskip': _A_in['Dskip'], 'B_x': _B_in['x'], 'B_w_in': _B_in['w_in'], 'B_w_sp': _B_in['w_sp'], 'B_b_sp': _B_in['b_sp'], 'B_w_out': _B_in['w_out'], 'c': _w((lambda *s: torch.randn(*s, dtype=torch.bfloat16) * 0.1)(1, 512) * 8.0), 'w_mod': _w((lambda *s: torch.randn(*s, dtype=torch.bfloat16) * 0.1)(512, 6 * 512) * 512 ** (-0.5) * 8.0)}

def reference(A_u, A_A_re, A_A_im, A_B_re, A_B_im, A_C_re, A_C_im, A_log_dt, A_Dskip, B_x, B_w_in, B_w_sp, B_b_sp, B_w_out, c, w_mod):

    def _A_ref(u, A_re, A_im, B_re, B_im, C_re, C_im, log_dt, Dskip):
        Bsz, L, D = u.shape
        dt = torch.exp(log_dt)[:, None]
        A = A_re + 1j * A_im
        Bc = B_re + 1j * B_im
        Cc = C_re + 1j * C_im
        logdA = dt * A
        dB = dt * Bc
        l = (lambda x, dt: x.to(dt))(torch.arange(L), A_re.dtype)
        P = torch.exp(logdA[:, :, None] * l[None, None, :])
        K = torch.einsum('dn,dnl,dn->dl', Cc, P, dB).real
        L2 = 2 * L
        Kp = _pad(K, ((0, 0), (0, L)))
        up = (lambda x, *d: x.permute(*d))(u, 0, 2, 1)
        up = _pad(up, ((0, 0), (0, 0), (0, L)))
        Kf = (lambda x, axes=(-2, -1): torch.fft.rfft2(x.float(), dim=axes))(Kp[:, None, :], axes=(-2, -1))
        Uf = (lambda x, axes=(-2, -1): torch.fft.rfft2(x.float(), dim=axes))(up[:, :, None, :], axes=(-2, -1))
        Yf = Uf * Kf[None, :, :, :]
        y = (lambda x, s, axes=(-2, -1): torch.fft.irfft2(x, s=s, dim=axes).to(torch.bfloat16))(Yf, (1, L2), axes=(-2, -1))[:, :, 0, :L]
        y = (lambda x, *d: x.permute(*d))(y, 0, 2, 1) + u * Dskip[None, None, :]
        return y

    def _B_ref(x, w_in, w_sp, b_sp, w_out):
        B, S, D = x.shape
        F = w_in.shape[-1]
        Fh = F // 2
        z = _gelu(torch.einsum('bsd,df->bsf', x, w_in))
        z1 = z[..., :Fh].clone()
        z2 = _layernorm(z[..., Fh:], axis=-1)
        g = torch.einsum('ts,bsf->btf', w_sp, z2) + b_sp[None, :, None]
        return torch.einsum('bsf,fd->bsd', z1 * g, w_out)
    x = A_u
    mod = (_silu(c) @ w_mod).reshape(c.shape[0], 6, 1, -1)
    sa, ca, ga, sb, cb, gb = (mod[:, 0].clone(), mod[:, 1].clone(), mod[:, 2].clone(), mod[:, 3].clone(), mod[:, 4].clone(), mod[:, 5].clone())
    h = _layernorm(x, axis=-1) * (1 + ca) + sa
    x = x + ga * _A_ref(h, A_A_re, A_A_im, A_B_re, A_B_im, A_C_re, A_C_im, A_log_dt, A_Dskip)
    h = _layernorm(x, axis=-1) * (1 + cb) + sb
    x = x + gb * _B_ref(h, B_w_in, B_w_sp, B_b_sp, B_w_out)
    return x
```

```asm
; @launch grid=(256,1,1) block=(512,1,1) lds=163840
.amdgcn_target "amdgcn-amd-amdhsa--gfx950"
.text
.globl adaLN_cond__ssm_conv_s4__mixer_gmlp__prompt_kernel
.p2align 8
.type adaLN_cond__ssm_conv_s4__mixer_gmlp__prompt_kernel,@function
.set PF_SLICE, 992
adaLN_cond__ssm_conv_s4__mixer_gmlp__prompt_kernel:
  s_cmp_ge_u32 s2, 256
  s_cbranch_scc1 L_END
  s_load_dwordx16 s[4:19], s[0:1], 0
  s_load_dwordx16 s[20:35], s[0:1], 64
  s_load_dwordx4 s[36:39], s[0:1], 128
  s_load_dwordx2 s[40:41], s[0:1], 144
  s_getpc_b64 s[48:49]
L_PFBASE:
  s_lshr_b32 s50, s2, 3
  s_mul_i32 s50, s50, PF_SLICE
  v_lshlrev_b32 v2, 4, v0
  v_cmp_gt_u32 vcc, PF_SLICE, v2
  v_add_u32 v2, s50, v2
  s_and_saveexec_b64 s[50:51], vcc
  s_cbranch_execz L_PF0
  global_load_dwordx4 v[252:255], v2, s[48:49]
L_PF0:
  s_mov_b64 exec, s[50:51]
  v_and_b32 v1, 63, v0
  v_lshrrev_b32 v2, 6, v0
  s_nop 0
  v_readfirstlane_b32 s42, v2
  s_and_b32 s47, s2, 7
  s_lshr_b32 s48, s2, 3
  s_lshl_b32 s44, s47, 5
  s_add_u32 s44, s44, s48
  s_lshr_b32 s45, s47, 1
  s_lshl_b32 s45, s45, 3
  s_lshr_b32 s49, s48, 2
  s_add_u32 s45, s45, s49
  s_and_b32 s46, s47, 1
  s_lshl_b32 s46, s46, 2
  s_and_b32 s49, s48, 3
  s_add_u32 s46, s46, s49
  s_lshl_b32 s47, s2, 13
  v_lshlrev_b32 v4, 4, v0
  v_add_u32 v4, s47, v4
  s_lshr_b32 s53, s42, 2
  s_lshl_b32 s52, s44, 1
  s_add_u32 s52, s52, s53
  s_lshl_b32 s50, s52, 8
  s_and_b32 s51, s42, 1
  s_lshl_b32 s51, s51, 7
  s_add_u32 s50, s50, s51
  v_lshlrev_b32 v5, 1, v1
  v_add_u32 v5, s50, v5
  s_lshl_b32 s50, s52, 1
  v_mov_b32 v6, s50
  s_lshr_b32 s51, s2, 3
  s_min_u32 s51, s51, 23
  s_mul_i32 s50, s51, 43
  s_lshr_b32 s50, s50, 8
  s_mul_i32 s55, s50, 6
  s_sub_u32 s51, s51, s55
  s_and_b32 s55, s2, 7
  s_mul_i32 s55, s55, 6
  s_add_u32 s54, s55, s51
  s_mov_b32 s59, s50
  v_lshrrev_b32 v8, 3, v0
  s_lshl_b32 s51, s50, 7
  v_add_u32 v8, s51, v8
  s_movk_i32 s50, 6144
  v_mul_lo_u32 v7, v8, s50
  v_and_b32 v9, 7, v0
  v_lshl_add_u32 v7, v9, 4, v7
  s_lshl_b32 s50, s54, 7
  v_add_u32 v7, s50, v7
  v_lshlrev_b32 v8, 1, v8
  v_lshrrev_b32 v56, 3, v1
  v_and_b32 v57, 7, v1
  v_xor_b32 v9, s42, v57
  v_lshlrev_b32 v9, 4, v9
  v_lshl_add_u32 v9, v56, 10, v9
  s_lshr_b32 s50, s2, 3
  s_lshl_b32 s50, s50, 16
  s_lshl_b32 s51, s42, 13
  s_add_u32 s50, s50, s51
  s_and_b32 s51, s2, 7
  s_lshl_b32 s51, s51, 7
  s_add_u32 s50, s50, s51
  v_add_u32 v9, s50, v9
  v_xor_b32 v63, s42, v57
  v_lshlrev_b32 v63, 4, v63
  v_lshl_add_u32 v63, v57, 10, v63
  v_lshl_add_u32 v63, v56, 1, v63
  v_lshlrev_b32 v62, 12, v56
  v_lshl_add_u32 v62, v57, 4, v62
  s_and_b32 s50, s2, 7
  s_lshl_b32 s50, s50, 18
  s_lshl_b32 s51, s42, 15
  s_add_u32 s50, s50, s51
  s_lshr_b32 s51, s2, 3
  s_lshl_b32 s51, s51, 7
  s_add_u32 s50, s50, s51
  s_add_u32 s50, s50, 22020096
  v_add_u32 v62, s50, v62
  v_mov_b32 v10, 20447232
  v_mov_b32 v52, -1
  v_mov_b32 v53, -1
  v_mov_b32 v54, -1
  v_mov_b32 v55, -1
  s_lshr_b32 s50, s2, 4
  s_mul_i32 s50, s50, 7
  s_min_u32 s51, s42, 6
  s_add_u32 s50, s50, s51
  s_lshl_b32 s50, s50, 4
  s_and_b32 s51, s2, 15
  s_add_u32 s50, s50, s51
  s_lshl_b32 s50, s50, 10
  s_add_u32 s50, s50, 9437184
  v_lshlrev_b32 v61, 4, v1
  v_add_u32 v61, s50, v61
  v_min_u32 v56, 447, v0
  v_mul_u32_u24 v57, 4682, v56
  v_lshrrev_b32 v57, 16, v57
  v_mul_u32_u24 v58, 14, v57
  v_sub_u32 v58, v56, v58
  s_and_b32 s50, s2, 15
  s_lshr_b32 s51, s2, 4
  s_lshl_b32 s55, s50, 5
  v_add_u32 v57, s55, v57
  s_movk_i32 s55, 3584
  v_mul_lo_u32 v57, v57, s55
  v_lshl_add_u32 v57, v58, 4, v57
  s_mul_i32 s55, s51, 224
  v_add_u32 v60, s55, v57
  s_waitcnt lgkmcnt(0)
  global_load_dwordx4 v[12:15], v4, s[4:5]
  s_lshl_b32 s55, s42, 10
  s_add_u32 m0, s55, 0
  s_nop 0
  global_load_lds_dwordx4 v9, s[4:5]
  global_load_dword v11, v10, s[40:41] sc1
  s_barrier
  global_load_ushort v24, v8, s[32:33] offset:0
  global_load_ushort v25, v8, s[32:33] offset:128
  global_load_dwordx4 v[64:67], v7, s[34:35]
  v_add_u32 v7, 393216, v7
  global_load_dwordx4 v[68:71], v7, s[34:35]
  v_and_b32 v96, 255, v0
  v_lshlrev_b32 v96, 3, v96
  v_sub_u32 v96, 2047, v96
  v_lshrrev_b32 v97, 8, v0
  v_mul_u32_u24 v97, 9232, v97
  v_add_u32 v97, 112584, v97
  v_subrev_u32 v112, 0, v96
  v_subrev_u32 v113, 1, v96
  v_max_i32 v112, -1, v112
  v_max_i32 v113, -1, v113
  v_cvt_f32_i32 v112, v112
  v_cvt_f32_i32 v113, v113
  v_cvt_pk_bf16_f32 v114, v112, v113
  v_lshlrev_b32 v112, 16, v114
  v_and_b32 v113, 0xffff0000, v114
  v_cvt_i32_f32 v112, v112
  v_cvt_i32_f32 v113, v113
  v_ashrrev_i32 v114, 3, v112
  v_add_u32 v112, v112, v114
  v_ashrrev_i32 v114, 3, v113
  v_add_u32 v113, v113, v114
  v_lshl_add_u32 v100, v112, 2, v97
  v_lshl_add_u32 v101, v113, 2, v97
  v_subrev_u32 v112, 2, v96
  v_subrev_u32 v113, 3, v96
  v_max_i32 v112, -1, v112
  v_max_i32 v113, -1, v113
  v_cvt_f32_i32 v112, v112
  v_cvt_f32_i32 v113, v113
  v_cvt_pk_bf16_f32 v114, v112, v113
  v_lshlrev_b32 v112, 16, v114
  v_and_b32 v113, 0xffff0000, v114
  v_cvt_i32_f32 v112, v112
  v_cvt_i32_f32 v113, v113
  v_ashrrev_i32 v114, 3, v112
  v_add_u32 v112, v112, v114
  v_ashrrev_i32 v114, 3, v113
  v_add_u32 v113, v113, v114
  v_lshl_add_u32 v102, v112, 2, v97
  v_lshl_add_u32 v103, v113, 2, v97
  v_subrev_u32 v112, 4, v96
  v_subrev_u32 v113, 5, v96
  v_max_i32 v112, -1, v112
  v_max_i32 v113, -1, v113
  v_cvt_f32_i32 v112, v112
  v_cvt_f32_i32 v113, v113
  v_cvt_pk_bf16_f32 v114, v112, v113
  v_lshlrev_b32 v112, 16, v114
  v_and_b32 v113, 0xffff0000, v114
  v_cvt_i32_f32 v112, v112
  v_cvt_i32_f32 v113, v113
  v_ashrrev_i32 v114, 3, v112
  v_add_u32 v112, v112, v114
  v_ashrrev_i32 v114, 3, v113
  v_add_u32 v113, v113, v114
  v_lshl_add_u32 v104, v112, 2, v97
  v_lshl_add_u32 v105, v113, 2, v97
  v_subrev_u32 v112, 6, v96
  v_subrev_u32 v113, 7, v96
  v_max_i32 v112, -1, v112
  v_max_i32 v113, -1, v113
  v_cvt_f32_i32 v112, v112
  v_cvt_f32_i32 v113, v113
  v_cvt_pk_bf16_f32 v114, v112, v113
  v_lshlrev_b32 v112, 16, v114
  v_and_b32 v113, 0xffff0000, v114
  v_cvt_i32_f32 v112, v112
  v_cvt_i32_f32 v113, v113
  v_ashrrev_i32 v114, 3, v112
  v_add_u32 v112, v112, v114
  v_ashrrev_i32 v114, 3, v113
  v_add_u32 v113, v113, v114
  v_lshl_add_u32 v106, v112, 2, v97
  v_lshl_add_u32 v107, v113, 2, v97
  v_subrev_u32 v112, 8, v96
  v_subrev_u32 v113, 9, v96
  v_max_i32 v112, -1, v112
  v_max_i32 v113, -1, v113
  v_cvt_f32_i32 v112, v112
  v_cvt_f32_i32 v113, v113
  v_cvt_pk_bf16_f32 v114, v112, v113
  v_lshlrev_b32 v112, 16, v114
  v_and_b32 v113, 0xffff0000, v114
  v_cvt_i32_f32 v112, v112
  v_cvt_i32_f32 v113, v113
  v_ashrrev_i32 v114, 3, v112
  v_add_u32 v112, v112, v114
  v_ashrrev_i32 v114, 3, v113
  v_add_u32 v113, v113, v114
  v_lshl_add_u32 v108, v112, 2, v97
  v_lshl_add_u32 v109, v113, 2, v97
  v_subrev_u32 v112, 10, v96
  v_subrev_u32 v113, 11, v96
  v_max_i32 v112, -1, v112
  v_max_i32 v113, -1, v113
  v_cvt_f32_i32 v112, v112
  v_cvt_f32_i32 v113, v113
  v_cvt_pk_bf16_f32 v114, v112, v113
  v_lshlrev_b32 v112, 16, v114
  v_and_b32 v113, 0xffff0000, v114
  v_cvt_i32_f32 v112, v112
  v_cvt_i32_f32 v113, v113
  v_ashrrev_i32 v114, 3, v112
  v_add_u32 v112, v112, v114
  v_ashrrev_i32 v114, 3, v113
  v_add_u32 v113, v113, v114
  v_lshl_add_u32 v110, v112, 2, v97
  v_lshrrev_b32 v111, 8, v0
  v_mul_u32_u24 v111, 16640, v111
  v_and_b32 v112, 255, v0
  v_lshl_add_u32 v111, v112, 4, v111
  v_add_u32 v111, 17344, v111
  global_load_ushort v16, v5, s[6:7]
  global_load_ushort v17, v5, s[8:9]
  global_load_ushort v18, v5, s[10:11]
  global_load_ushort v19, v5, s[12:13]
  global_load_ushort v20, v5, s[14:15]
  global_load_ushort v21, v5, s[16:17]
  global_load_ushort v22, v6, s[18:19]
  global_load_ushort v23, v6, s[20:21]
  s_lshl_b32 s55, s42, 10
  s_add_u32 m0, s55, 19392
  s_nop 0
  global_load_lds_dwordx4 v60, s[24:25]
  global_store_dwordx4 v4, v[52:55], s[40:41] sc1
  global_store_dwordx4 v61, v[52:55], s[40:41] sc1
  v_and_b32 v99, 7, v1
  v_lshlrev_b32 v99, 5, v99
  v_bfe_u32 v112, v1, 4, 1
  v_lshl_add_u32 v99, v112, 3, v99
  v_lshrrev_b32 v112, 5, v1
  v_lshl_add_u32 v99, v112, 2, v99
  s_lshl_b32 s50, s42, 8
  s_add_u32 s50, s50, 17344
  v_add_u32 v99, s50, v99
  v_lshrrev_b32 v98, 4, v1
  v_lshlrev_b32 v98, 3, v98
  v_bfe_u32 v112, v1, 2, 2
  v_add_u32 v98, v98, v112
  v_mul_u32_u24 v98, 224, v98
  v_and_b32 v112, 3, v1
  v_lshl_add_u32 v98, v112, 3, v98
  s_lshl_b32 s50, s42, 5
  s_add_u32 s50, s50, 19392
  v_add_u32 v98, s50, v98
  v_mov_b32 v112, 0
  v_mov_b32 v113, 0
  v_mov_b32 v114, 0
  v_mov_b32 v115, 0
  s_cmp_lt_u32 s42, 2
  s_cbranch_scc0 L_Z1
  s_mul_i32 s50, s42, 4576
  s_add_u32 s50, s50, 8192
  v_lshlrev_b32 v116, 4, v1
  v_add_u32 v116, s50, v116
  s_mov_b64 exec, 0x3fffffff
  ds_write_b128 v116, v[112:115]
  s_mov_b64 exec, -1
  s_branch L_Z2
L_Z1:
  s_cmp_eq_u32 s42, 2
  s_cbranch_scc0 L_Z2
  v_mov_b32 v116, 112576
  ds_write_b32 v116, v112
  ds_write_b32 v116, v112 offset:9232
L_Z2:
  v_and_b32 v116, 15, v1
  v_lshrrev_b32 v117, 4, v1
  v_mul_u32_u24 v176, 544, v116
  v_lshl_add_u32 v176, v117, 4, v176
  s_mul_i32 s51, s53, 30976
  s_add_u32 s51, s51, 50624
  v_add_u32 v176, s51, v176
  s_and_b32 s50, s42, 3
  s_mul_i32 s51, s50, 8704
  v_add_u32 v177, s51, v176
  v_lshlrev_b32 v118, 3, v116
  s_cmp_eq_u32 s50, 0
  s_cbranch_scc0 L_SC1
  v_lshrrev_b32 v119, 1, v117
  v_lshl_add_u32 v118, v119, 7, v118
  v_and_b32 v119, 1, v117
  v_lshl_add_u32 v118, v119, 2, v118
  v_mov_b32 v120, 1
  s_branch L_SC3
L_SC1:
  s_cmp_eq_u32 s50, 1
  s_cbranch_scc0 L_SC2
  v_lshlrev_b32 v119, 7, v117
  v_add_u32 v119, 256, v119
  v_lshlrev_b32 v121, 2, v117
  v_add_u32 v121, 504, v121
  v_cmp_gt_u32 vcc, 2, v117
  s_nop 1
  v_cndmask_b32 v119, v121, v119, vcc
  v_mov_b32 v121, 128
  v_mov_b32 v120, 2
  v_cndmask_b32 v120, v121, v120, vcc
  v_add_u32 v118, v118, v119
  s_branch L_SC3
L_SC2:
  v_lshl_add_u32 v118, v117, 9, v118
  v_add_u32 v118, 1024, v118
  v_mov_b32 v120, 128
L_SC3:
  s_mul_i32 s51, s53, 9232
  s_add_u32 s51, s51, 112584
  v_min_u32 v119, 2049, v118
  v_lshrrev_b32 v121, 3, v119
  v_add_u32 v119, v119, v121
  v_lshlrev_b32 v119, 2, v119
  v_add_u32 v178, s51, v119
  v_add_u32 v118, v118, v120
  v_min_u32 v119, 2049, v118
  v_lshrrev_b32 v121, 3, v119
  v_add_u32 v119, v119, v121
  v_lshlrev_b32 v119, 2, v119
  v_add_u32 v179, s51, v119
  v_add_u32 v118, v118, v120
  v_min_u32 v119, 2049, v118
  v_lshrrev_b32 v121, 3, v119
  v_add_u32 v119, v119, v121
  v_lshlrev_b32 v119, 2, v119
  v_add_u32 v180, s51, v119
  v_add_u32 v118, v118, v120
  v_min_u32 v119, 2049, v118
  v_lshrrev_b32 v121, 3, v119
  v_add_u32 v119, v119, v121
  v_lshlrev_b32 v119, 2, v119
  v_add_u32 v181, s51, v119
  v_lshlrev_b32 v160, 5, v0
  v_add_u32 v160, 19922944, v160
  v_lshrrev_b32 v161, 2, v1
  v_min_u32 v161, 5, v161
  v_lshrrev_b32 v116, 1, v161
  v_lshlrev_b32 v116, 9, v116
  v_and_b32 v161, 1, v161
  v_add_u32 v161, v161, v116
  s_lshl_b32 s50, s44, 1
  v_add_u32 v161, s50, v161
  v_lshlrev_b32 v161, 2, v161
  v_and_b32 v116, 3, v1
  v_add_u32 v161, v161, v116
  v_lshlrev_b32 v161, 3, v161
  v_add_u32 v161, 20250624, v161
  v_lshlrev_b32 v164, 3, v0
  v_add_u32 v164, 8672, v164
  v_and_b32 v112, 15, v1
  v_lshrrev_b32 v113, 4, v1
  v_sub_u32 v114, 3, v112
  v_and_b32 v114, 3, v114
  v_mul_u32_u24 v115, 4160, v114
  v_sub_u32 v116, 2031, v112
  v_sub_u32 v116, v116, v114
  v_lshl_add_u32 v115, v116, 1, v115
  v_lshlrev_b32 v116, 4, v113
  v_add_u32 v115, v115, v116
  s_mul_i32 s50, s53, 16640
  s_add_u32 s50, s50, 13760
  s_and_b32 s51, s42, 3
  s_lshl_b32 s55, s51, 7
  s_sub_u32 s50, s50, s55
  v_add_u32 v165, s50, v115
  v_lshl_add_u32 v115, v112, 5, v116
  s_mul_i32 s50, s53, 4576
  s_add_u32 s50, s50, 8640
  s_sub_u32 s50, s50, s55
  v_add_u32 v166, s50, v115
  s_mov_b32 s62, s51
  s_sub_u32 s63, 7, s51
  v_bfe_u32 v167, v1, 4, 2
  v_lshlrev_b32 v167, 3, v167
  v_and_b32 v116, 7, v1
  v_add_u32 v167, v167, v116
  s_lshl_b32 s50, s42, 5
  v_add_u32 v167, s50, v167
  v_lshlrev_b32 v167, 3, v167
  v_add_u32 v167, 20226048, v167
  v_lshrrev_b32 v116, 5, v1
  s_lshl_b32 s50, s42, 3
  v_add_u32 v116, s50, v116
  v_and_b32 v117, 31, v1
  s_lshl_b32 s50, s45, 18
  s_lshl_b32 s51, s46, 9
  s_add_u32 s50, s50, s51
  v_and_b32 v118, 15, v116
  v_xor_b32 v118, v117, v118
  v_lshlrev_b32 v118, 4, v118
  v_lshl_add_u32 v118, v116, 12, v118
  v_add_u32 v175, s50, v118
  v_and_b32 v116, 15, v1
  v_lshrrev_b32 v117, 4, v1
  s_lshr_b32 s50, s42, 1
  s_lshl_b32 s50, s50, 13
  s_add_u32 s50, s50, 131072
  v_lshlrev_b32 v118, 9, v116
  v_add_u32 v118, s50, v118
  s_and_b32 s51, s42, 1
  s_lshl_b32 s51, s51, 4
  v_add_u32 v119, 0, v117
  v_add_u32 v119, s51, v119
  v_xor_b32 v119, v119, v116
  v_lshl_add_u32 v168, v119, 4, v118
  v_add_u32 v119, 4, v117
  v_add_u32 v119, s51, v119
  v_xor_b32 v119, v119, v116
  v_lshl_add_u32 v169, v119, 4, v118
  v_add_u32 v119, 8, v117
  v_add_u32 v119, s51, v119
  v_xor_b32 v119, v119, v116
  v_lshl_add_u32 v170, v119, 4, v118
  v_add_u32 v119, 12, v117
  v_add_u32 v119, s51, v119
  v_xor_b32 v119, v119, v116
  v_lshl_add_u32 v171, v119, 4, v118
  s_lshl_b32 s50, s44, 13
  s_add_u32 s50, s50, 22020096
  v_lshlrev_b32 v163, 3, v0
  v_add_u32 v163, s50, v163
  v_add_u32 v172, 4096, v163
  s_lshl_b32 s50, s45, 3
  s_add_u32 s50, s50, s46
  s_lshl_b32 s50, s50, 15
  s_lshr_b32 s55, s42, 1
  s_lshl_b32 s55, s55, 13
  s_add_u32 s50, s50, s55
  s_and_b32 s51, s42, 1
  s_lshl_b32 s51, s51, 12
  s_add_u32 s50, s50, s51
  s_add_u32 s50, s50, 11534336
  v_lshlrev_b32 v174, 4, v1
  v_add_u32 v174, s50, v174
  s_waitcnt vmcnt(17)
  v_lshlrev_b32 v40, 16, v12
  v_and_b32 v41, 0xffff0000, v12
  v_lshlrev_b32 v42, 16, v13
  v_and_b32 v43, 0xffff0000, v13
  v_lshlrev_b32 v44, 16, v14
  v_and_b32 v45, 0xffff0000, v14
  v_lshlrev_b32 v46, 16, v15
  v_and_b32 v47, 0xffff0000, v15
  v_add_f32 v48, v40, v41
  v_add_f32 v49, v42, v43
  v_add_f32 v50, v44, v45
  v_add_f32 v51, v46, v47
  v_add_f32 v48, v48, v49
  v_add_f32 v50, v50, v51
  v_add_f32 v48, v48, v50
  s_nop 1
  v_add_f32_dpp v48, v48, v48 row_shr:1 row_mask:0xf bank_mask:0xf bound_ctrl:0
  s_nop 1
  v_add_f32_dpp v48, v48, v48 row_shr:2 row_mask:0xf bank_mask:0xf bound_ctrl:0
  s_nop 1
  v_add_f32_dpp v48, v48, v48 row_shr:4 row_mask:0xf bank_mask:0xf bound_ctrl:0
  s_nop 1
  v_add_f32_dpp v48, v48, v48 row_shr:8 row_mask:0xf bank_mask:0xf bound_ctrl:0
  s_nop 1
  v_add_f32_dpp v48, v48, v48 row_bcast:15 row_mask:0xa bank_mask:0xf
  s_nop 1
  v_add_f32_dpp v48, v48, v48 row_bcast:31 row_mask:0xc bank_mask:0xf
  s_nop 0
  v_readlane_b32 s56, v48, 63
  s_nop 1
  v_mov_b32 v49, s56
  v_mul_f32 v49, 0x3b000000, v49
  v_sub_f32 v40, v40, v49
  v_sub_f32 v41, v41, v49
  v_sub_f32 v42, v42, v49
  v_sub_f32 v43, v43, v49
  v_sub_f32 v44, v44, v49
  v_sub_f32 v45, v45, v49
  v_sub_f32 v46, v46, v49
  v_sub_f32 v47, v47, v49
  v_mul_f32 v48, v40, v40
  v_mul_f32 v50, v41, v41
  v_fma_f32 v48, v42, v42, v48
  v_fma_f32 v50, v43, v43, v50
  v_fma_f32 v48, v44, v44, v48
  v_fma_f32 v50, v45, v45, v50
  v_fma_f32 v48, v46, v46, v48
  v_fma_f32 v50, v47, v47, v50
  v_add_f32 v48, v48, v50
  s_nop 1
  v_add_f32_dpp v48, v48, v48 row_shr:1 row_mask:0xf bank_mask:0xf bound_ctrl:0
  s_nop 1
  v_add_f32_dpp v48, v48, v48 row_shr:2 row_mask:0xf bank_mask:0xf bound_ctrl:0
  s_nop 1
  v_add_f32_dpp v48, v48, v48 row_shr:4 row_mask:0xf bank_mask:0xf bound_ctrl:0
  s_nop 1
  v_add_f32_dpp v48, v48, v48 row_shr:8 row_mask:0xf bank_mask:0xf bound_ctrl:0
  s_nop 1
  v_add_f32_dpp v48, v48, v48 row_bcast:15 row_mask:0xa bank_mask:0xf
  s_nop 1
  v_add_f32_dpp v48, v48, v48 row_bcast:31 row_mask:0xc bank_mask:0xf
  s_nop 0
  v_readlane_b32 s57, v48, 63
  s_nop 1
  v_mov_b32 v50, s57
  v_mul_f32 v50, 0x3b000000, v50
  v_cvt_pk_bf16_f32 v51, v50, v50
  v_and_b32 v50, 0xffff0000, v51
  v_add_f32 v50, 0x3727c5ac, v50
  v_cvt_pk_bf16_f32 v51, v50, v50
  v_and_b32 v50, 0xffff0000, v51
  v_sqrt_f32 v50, v50
  s_waitcnt vmcnt(15)
  v_readfirstlane_b32 s43, v11
  v_cvt_pk_bf16_f32 v56, v49, v50
  s_add_u32 s43, s43, 1
  v_mov_b32 v57, s43
  v_mov_b32 v3, s43
  s_lshl_b32 s50, s2, 6
  s_lshl_b32 s51, s42, 3
  s_add_u32 s50, s50, s51
  s_add_u32 s50, s50, 19922944
  v_mov_b32 v58, s50
  s_mov_b64 exec, 1
  global_store_dwordx2 v58, v[56:57], s[40:41] sc1
  s_mov_b64 exec, -1
  s_barrier
  ds_read_u16 v40, v63 offset:0
  ds_read_u16_d16_hi v44, v63 offset:128
  ds_read_u16 v41, v63 offset:256
  ds_read_u16_d16_hi v45, v63 offset:384
  ds_read_u16 v42, v63 offset:512
  ds_read_u16_d16_hi v46, v63 offset:640
  ds_read_u16 v43, v63 offset:768
  ds_read_u16_d16_hi v47, v63 offset:896
  s_waitcnt lgkmcnt(0)
  v_and_b32 v44, 0xffff0000, v44
  v_and_b32 v45, 0xffff0000, v45
  v_and_b32 v46, 0xffff0000, v46
  v_and_b32 v47, 0xffff0000, v47
  v_or_b32 v40, v40, v44
  v_or_b32 v41, v41, v45
  v_or_b32 v42, v42, v46
  v_or_b32 v43, v43, v47
  global_store_dwordx4 v62, v[40:43], s[40:41] sc1
  s_waitcnt vmcnt(13)
  v_lshlrev_b32 v24, 16, v24
  v_lshlrev_b32 v25, 16, v25
  v_mul_f32 v56, 0xbfb8aa3b, v24
  v_mul_f32 v57, 0xbfb8aa3b, v25
  v_exp_f32 v56, v56
  v_exp_f32 v57, v57
  v_add_f32 v56, 1.0, v56
  v_add_f32 v57, 1.0, v57
  v_rcp_f32 v56, v56
  v_rcp_f32 v57, v57
  v_mul_f32 v24, v24, v56
  v_mul_f32 v25, v25, v57
  v_cvt_pk_bf16_f32 v56, v24, v25
  v_lshlrev_b32 v24, 16, v56
  v_and_b32 v25, 0xffff0000, v56
  v_lshlrev_b32 v56, 16, v64
  v_and_b32 v57, 0xffff0000, v64
  v_mul_f32 v40, v24, v56
  v_mul_f32 v41, v24, v57
  v_lshlrev_b32 v58, 16, v65
  v_and_b32 v59, 0xffff0000, v65
  v_mul_f32 v42, v24, v58
  v_mul_f32 v43, v24, v59
  v_lshlrev_b32 v56, 16, v66
  v_and_b32 v57, 0xffff0000, v66
  v_mul_f32 v44, v24, v56
  v_mul_f32 v45, v24, v57
  v_lshlrev_b32 v58, 16, v67
  v_and_b32 v59, 0xffff0000, v67
  v_mul_f32 v46, v24, v58
  v_mul_f32 v47, v24, v59
  v_lshlrev_b32 v56, 16, v68
  v_and_b32 v57, 0xffff0000, v68
  v_fmac_f32 v40, v25, v56
  v_fmac_f32 v41, v25, v57
  v_lshlrev_b32 v58, 16, v69
  v_and_b32 v59, 0xffff0000, v69
  v_fmac_f32 v42, v25, v58
  v_fmac_f32 v43, v25, v59
  v_lshlrev_b32 v56, 16, v70
  v_and_b32 v57, 0xffff0000, v70
  v_fmac_f32 v44, v25, v56
  v_fmac_f32 v45, v25, v57
  v_lshlrev_b32 v58, 16, v71
  v_and_b32 v59, 0xffff0000, v71
  v_fmac_f32 v46, v25, v58
  v_fmac_f32 v47, v25, v59
  v_permlane32_swap_b32 v40, v41
  v_permlane32_swap_b32 v42, v43
  v_permlane32_swap_b32 v44, v45
  v_permlane32_swap_b32 v46, v47
  v_add_f32 v40, v40, v41
  v_add_f32 v42, v42, v43
  v_add_f32 v44, v44, v45
  v_add_f32 v46, v46, v47
  v_permlane16_swap_b32 v40, v42
  s_nop 0
  v_permlane16_swap_b32 v44, v46
  v_add_f32 v40, v40, v42
  v_add_f32 v44, v44, v46
  s_nop 0
  v_add_f32_dpp v40, v40, v40 row_ror:8 row_mask:0xf bank_mask:0xf
  v_add_f32_dpp v44, v44, v44 row_ror:8 row_mask:0xf bank_mask:0xf
  ds_write_b32 v99, v40
  ds_write_b32 v99, v44 offset:16
  s_waitcnt vmcnt(5)
  v_lshlrev_b32 v16, 16, v16
  v_lshlrev_b32 v17, 16, v17
  v_lshlrev_b32 v18, 16, v18
  v_lshlrev_b32 v19, 16, v19
  v_lshlrev_b32 v20, 16, v20
  v_lshlrev_b32 v21, 16, v21
  v_lshlrev_b32 v22, 16, v22
  v_mul_f32 v22, 0x3fb8aa3b, v22
  v_exp_f32 v22, v22
  s_nop 0
  v_cvt_pk_bf16_f32 v25, v22, v22
  v_lshlrev_b32 v22, 16, v25
  v_and_b32 v24, 0xffff0000, v25
  v_mul_f32 v16, v22, v16
  v_mul_f32 v17, v22, v17
  v_mul_f32 v18, v22, v18
  v_mul_f32 v19, v22, v19
  v_pk_mul_f32 v[26:27], v[20:21], v[18:19] op_sel:[0,0] op_sel_hi:[1,0]
  v_pk_fma_f32 v[24:25], v[20:21], v[18:19], v[26:27] op_sel:[1,1,0] op_sel_hi:[0,1,1] neg_lo:[1,0,0]
  v_mul_f32 v16, 0x3fb8aa3b, v16
  v_mul_f32 v17, 0x3e22f983, v17
  v_mul_f32 v26, 0x3f800000, v16
  v_mul_f32 v27, 0x3f800000, v17
  v_exp_f32 v26, v26
  v_fract_f32 v27, v27
  v_cos_f32 v28, v27
  v_sin_f32 v29, v27
  v_mul_f32 v28, v28, v26
  v_mul_f32 v29, v29, v26
  v_mul_f32 v44, 0x43000000, v16
  v_mul_f32 v45, 0x43000000, v17
  v_exp_f32 v44, v44
  v_fract_f32 v45, v45
  v_cos_f32 v32, v45
  v_sin_f32 v33, v45
  v_mul_f32 v32, v32, v44
  v_mul_f32 v33, v33, v44
  s_mul_i32 s50, s53, 30976
  s_and_b32 s51, s42, 1
  s_lshl_b32 s51, s51, 8
  s_add_u32 s50, s50, s51
  s_add_u32 s50, s50, 50624
  v_lshlrev_b32 v34, 2, v1
  v_add_u32 v34, s50, v34
  s_waitcnt vmcnt(0)
  s_waitcnt lgkmcnt(0)
  s_barrier
  s_cmp_eq_u32 s42, 7
  s_cbranch_scc0 L_M1
  s_lshl_b32 s50, s2, 3
  s_add_u32 s50, s50, 20226048
  v_mov_b32 v56, s50
  v_mov_b32 v58, s43
  v_mov_b32 v59, s43
  s_mov_b64 exec, 1
  global_store_dwordx2 v56, v[58:59], s[40:41] sc1
  s_mov_b64 exec, -1
  s_cmp_lt_u32 s2, 192
  s_cbranch_scc0 L_M2
  v_lshlrev_b32 v56, 2, v1
  v_add_u32 v56, 17344, v56
  ds_read_b32 v80, v56 offset:0
  ds_read_b32 v81, v56 offset:256
  ds_read_b32 v82, v56 offset:512
  ds_read_b32 v83, v56 offset:768
  ds_read_b32 v84, v56 offset:1024
  ds_read_b32 v85, v56 offset:1280
  ds_read_b32 v86, v56 offset:1536
  ds_read_b32 v87, v56 offset:1792
  s_lshl_b32 s50, s54, 11
  s_lshl_b32 s51, s59, 3
  s_add_u32 s50, s50, s51
  s_add_u32 s50, s50, 20250624
  v_lshlrev_b32 v56, 5, v1
  v_add_u32 v56, s50, v56
  s_waitcnt lgkmcnt(0)
  v_add_f32 v80, v80, v81
  v_add_f32 v82, v82, v83
  v_add_f32 v84, v84, v85
  v_add_f32 v86, v86, v87
  v_add_f32 v80, v80, v82
  v_add_f32 v84, v84, v86
  v_add_f32 v80, v80, v84
  v_mov_b32 v81, s43
  global_store_dwordx2 v56, v[80:81], s[40:41] sc1
  s_branch L_M2
L_M1:
  ds_read_b64_tr_b16 v[40:41], v98
  ds_read_b64_tr_b16 v[42:43], v98 offset:896
  s_waitcnt lgkmcnt(0)
  global_store_dwordx4 v61, v[40:43], s[40:41] sc1
L_M2:
  s_bitcmp1_b32 s42, 1
  s_cbranch_scc1 L_KG1
  v_mul_f32 v26, 0x41000000, v16
  v_mul_f32 v27, 0x41000000, v17
  v_exp_f32 v26, v26
  v_fract_f32 v27, v27
  v_cos_f32 v30, v27
  v_sin_f32 v31, v27
  v_mul_f32 v30, v30, v26
  v_mul_f32 v31, v31, v26
  v_mov_b32 v35, 0x3f80
  ds_write_b32 v34, v35 offset:22304
  v_cvt_pk_bf16_f32 v35, v30, -v31
  ds_write_b32 v34, v35 offset:22848
  v_mov_b32 v36, v30
  v_mov_b32 v37, v31
  v_mov_b32 v38, v24
  v_mov_b32 v39, v25
  v_pk_mul_f32 v[26:27], v[36:37], v[30:31] op_sel:[0,0] op_sel_hi:[1,0]
  v_pk_fma_f32 v[36:37], v[36:37], v[30:31], v[26:27] op_sel:[1,1,0] op_sel_hi:[0,1,1] neg_lo:[1,0,0]
  v_cvt_pk_bf16_f32 v60, v38, v39
  ds_write_b32 v34, v60 offset:0
  v_pk_mul_f32 v[58:59], v[38:39], v[32:33] op_sel:[0,0] op_sel_hi:[1,0]
  v_pk_fma_f32 v[40:41], v[38:39], v[32:33], v[58:59] op_sel:[1,1,0] op_sel_hi:[0,1,1] neg_lo:[1,0,0]
  v_cvt_pk_bf16_f32 v62, v40, v41
  ds_write_b32 v34, v62 offset:4352
  v_cvt_pk_bf16_f32 v63, v36, -v37
  ds_write_b32 v34, v63 offset:23392
  v_pk_mul_f32 v[26:27], v[36:37], v[30:31] op_sel:[0,0] op_sel_hi:[1,0]
  v_pk_fma_f32 v[36:37], v[36:37], v[30:31], v[26:27] op_sel:[1,1,0] op_sel_hi:[0,1,1] neg_lo:[1,0,0]
  v_pk_mul_f32 v[58:59], v[38:39], v[28:29] op_sel:[0,0] op_sel_hi:[1,0]
  v_pk_fma_f32 v[38:39], v[38:39], v[28:29], v[58:59] op_sel:[1,1,0] op_sel_hi:[0,1,1] neg_lo:[1,0,0]
  v_cvt_pk_bf16_f32 v35, v38, v39
  ds_write_b32 v34, v35 offset:544
  v_pk_mul_f32 v[58:59], v[38:39], v[32:33] op_sel:[0,0] op_sel_hi:[1,0]
  v_pk_fma_f32 v[40:41], v[38:39], v[32:33], v[58:59] op_sel:[1,1,0] op_sel_hi:[0,1,1] neg_lo:[1,0,0]
  v_cvt_pk_bf16_f32 v60, v40, v41
  ds_write_b32 v34, v60 offset:4896
  v_cvt_pk_bf16_f32 v62, v36, -v37
  ds_write_b32 v34, v62 offset:23936
  v_pk_mul_f32 v[26:27], v[36:37], v[30:31] op_sel:[0,0] op_sel_hi:[1,0]
  v_pk_fma_f32 v[36:37], v[36:37], v[30:31], v[26:27] op_sel:[1,1,0] op_sel_hi:[0,1,1] neg_lo:[1,0,0]
  v_pk_mul_f32 v[58:59], v[38:39], v[28:29] op_sel:[0,0] op_sel_hi:[1,0]
  v_pk_fma_f32 v[38:39], v[38:39], v[28:29], v[58:59] op_sel:[1,1,0] op_sel_hi:[0,1,1] neg_lo:[1,0,0]
  v_cvt_pk_bf16_f32 v63, v38, v39
  ds_write_b32 v34, v63 offset:1088
  v_pk_mul_f32 v[58:59], v[38:39], v[32:33] op_sel:[0,0] op_sel_hi:[1,0]
  v_pk_fma_f32 v[40:41], v[38:39], v[32:33], v[58:59] op_sel:[1,1,0] op_sel_hi:[0,1,1] neg_lo:[1,0,0]
  v_cvt_pk_bf16_f32 v35, v40, v41
  ds_write_b32 v34, v35 offset:5440
  v_cvt_pk_bf16_f32 v60, v36, -v37
  ds_write_b32 v34, v60 offset:24480
  v_pk_mul_f32 v[26:27], v[36:37], v[30:31] op_sel:[0,0] op_sel_hi:[1,0]
  v_pk_fma_f32 v[36:37], v[36:37], v[30:31], v[26:27] op_sel:[1,1,0] op_sel_hi:[0,1,1] neg_lo:[1,0,0]
  v_pk_mul_f32 v[58:59], v[38:39], v[28:29] op_sel:[0,0] op_sel_hi:[1,0]
  v_pk_fma_f32 v[38:39], v[38:39], v[28:29], v[58:59] op_sel:[1,1,0] op_sel_hi:[0,1,1] neg_lo:[1,0,0]
  v_cvt_pk_bf16_f32 v62, v38, v39
  ds_write_b32 v34, v62 offset:1632
  v_pk_mul_f32 v[58:59], v[38:39], v[32:33] op_sel:[0,0] op_sel_hi:[1,0]
  v_pk_fma_f32 v[40:41], v[38:39], v[32:33], v[58:59] op_sel:[1,1,0] op_sel_hi:[0,1,1] neg_lo:[1,0,0]
  v_cvt_pk_bf16_f32 v63, v40, v41
  ds_write_b32 v34, v63 offset:5984
  v_cvt_pk_bf16_f32 v35, v36, -v37
  ds_write_b32 v34, v35 offset:25024
  v_pk_mul_f32 v[26:27], v[36:37], v[30:31] op_sel:[0,0] op_sel_hi:[1,0]
  v_pk_fma_f32 v[36:37], v[36:37], v[30:31], v[26:27] op_sel:[1,1,0] op_sel_hi:[0,1,1] neg_lo:[1,0,0]
  v_pk_mul_f32 v[58:59], v[38:39], v[28:29] op_sel:[0,0] op_sel_hi:[1,0]
  v_pk_fma_f32 v[38:39], v[38:39], v[28:29], v[58:59] op_sel:[1,1,0] op_sel_hi:[0,1,1] neg_lo:[1,0,0]
  v_cvt_pk_bf16_f32 v60, v38, v39
  ds_write_b32 v34, v60 offset:2176
  v_pk_mul_f32 v[58:59], v[38:39], v[32:33] op_sel:[0,0] op_sel_hi:[1,0]
  v_pk_fma_f32 v[40:41], v[38:39], v[32:33], v[58:59] op_sel:[1,1,0] op_sel_hi:[0,1,1] neg_lo:[1,0,0]
  v_cvt_pk_bf16_f32 v62, v40, v41
  ds_write_b32 v34, v62 offset:6528
  v_cvt_pk_bf16_f32 v63, v36, -v37
  ds_write_b32 v34, v63 offset:25568
  v_pk_mul_f32 v[26:27], v[36:37], v[30:31] op_sel:[0,0] op_sel_hi:[1,0]
  v_pk_fma_f32 v[36:37], v[36:37], v[30:31], v[26:27] op_sel:[1,1,0] op_sel_hi:[0,1,1] neg_lo:[1,0,0]
  v_pk_mul_f32 v[58:59], v[38:39], v[28:29] op_sel:[0,0] op_sel_hi:[1,0]
  v_pk_fma_f32 v[38:39], v[38:39], v[28:29], v[58:59] op_sel:[1,1,0] op_sel_hi:[0,1,1] neg_lo:[1,0,0]
  v_cvt_pk_bf16_f32 v35, v38, v39
  ds_write_b32 v34, v35 offset:2720
  v_pk_mul_f32 v[58:59], v[38:39], v[32:33] op_sel:[0,0] op_sel_hi:[1,0]
  v_pk_fma_f32 v[40:41], v[38:39], v[32:33], v[58:59] op_sel:[1,1,0] op_sel_hi:[0,1,1] neg_lo:[1,0,0]
  v_cvt_pk_bf16_f32 v60, v40, v41
  ds_write_b32 v34, v60 offset:7072
  v_cvt_pk_bf16_f32 v62, v36, -v37
  ds_write_b32 v34, v62 offset:26112
  v_pk_mul_f32 v[26:27], v[36:37], v[30:31] op_sel:[0,0] op_sel_hi:[1,0]
  v_pk_fma_f32 v[36:37], v[36:37], v[30:31], v[26:27] op_sel:[1,1,0] op_sel_hi:[0,1,1] neg_lo:[1,0,0]
  v_pk_mul_f32 v[58:59], v[38:39], v[28:29] op_sel:[0,0] op_sel_hi:[1,0]
  v_pk_fma_f32 v[38:39], v[38:39], v[28:29], v[58:59] op_sel:[1,1,0] op_sel_hi:[0,1,1] neg_lo:[1,0,0]
  v_cvt_pk_bf16_f32 v63, v38, v39
  ds_write_b32 v34, v63 offset:3264
  v_pk_mul_f32 v[58:59], v[38:39], v[32:33] op_sel:[0,0] op_sel_hi:[1,0]
  v_pk_fma_f32 v[40:41], v[38:39], v[32:33], v[58:59] op_sel:[1,1,0] op_sel_hi:[0,1,1] neg_lo:[1,0,0]
  v_cvt_pk_bf16_f32 v35, v40, v41
  ds_write_b32 v34, v35 offset:7616
  v_cvt_pk_bf16_f32 v60, v36, -v37
  ds_write_b32 v34, v60 offset:26656
  v_pk_mul_f32 v[26:27], v[36:37], v[30:31] op_sel:[0,0] op_sel_hi:[1,0]
  v_pk_fma_f32 v[36:37], v[36:37], v[30:31], v[26:27] op_sel:[1,1,0] op_sel_hi:[0,1,1] neg_lo:[1,0,0]
  v_pk_mul_f32 v[58:59], v[38:39], v[28:29] op_sel:[0,0] op_sel_hi:[1,0]
  v_pk_fma_f32 v[38:39], v[38:39], v[28:29], v[58:59] op_sel:[1,1,0] op_sel_hi:[0,1,1] neg_lo:[1,0,0]
  v_cvt_pk_bf16_f32 v62, v38, v39
  ds_write_b32 v34, v62 offset:3808
  v_pk_mul_f32 v[58:59], v[38:39], v[32:33] op_sel:[0,0] op_sel_hi:[1,0]
  v_pk_fma_f32 v[40:41], v[38:39], v[32:33], v[58:59] op_sel:[1,1,0] op_sel_hi:[0,1,1] neg_lo:[1,0,0]
  v_cvt_pk_bf16_f32 v63, v40, v41
  ds_write_b32 v34, v63 offset:8160
  v_cvt_pk_bf16_f32 v35, v36, -v37
  ds_write_b32 v34, v35 offset:27200
  v_pk_mul_f32 v[26:27], v[36:37], v[30:31] op_sel:[0,0] op_sel_hi:[1,0]
  v_pk_fma_f32 v[36:37], v[36:37], v[30:31], v[26:27] op_sel:[1,1,0] op_sel_hi:[0,1,1] neg_lo:[1,0,0]
  v_cvt_pk_bf16_f32 v60, v36, -v37
  ds_write_b32 v34, v60 offset:27744
  v_pk_mul_f32 v[26:27], v[36:37], v[30:31] op_sel:[0,0] op_sel_hi:[1,0]
  v_pk_fma_f32 v[36:37], v[36:37], v[30:31], v[26:27] op_sel:[1,1,0] op_sel_hi:[0,1,1] neg_lo:[1,0,0]
  v_cvt_pk_bf16_f32 v62, v36, -v37
  ds_write_b32 v34, v62 offset:28288
  v_pk_mul_f32 v[26:27], v[36:37], v[30:31] op_sel:[0,0] op_sel_hi:[1,0]
  v_pk_fma_f32 v[36:37], v[36:37], v[30:31], v[26:27] op_sel:[1,1,0] op_sel_hi:[0,1,1] neg_lo:[1,0,0]
  v_cvt_pk_bf16_f32 v63, v36, -v37
  ds_write_b32 v34, v63 offset:28832
  v_pk_mul_f32 v[26:27], v[36:37], v[30:31] op_sel:[0,0] op_sel_hi:[1,0]
  v_pk_fma_f32 v[36:37], v[36:37], v[30:31], v[26:27] op_sel:[1,1,0] op_sel_hi:[0,1,1] neg_lo:[1,0,0]
  v_cvt_pk_bf16_f32 v35, v36, -v37
  ds_write_b32 v34, v35 offset:29376
  v_pk_mul_f32 v[26:27], v[36:37], v[30:31] op_sel:[0,0] op_sel_hi:[1,0]
  v_pk_fma_f32 v[36:37], v[36:37], v[30:31], v[26:27] op_sel:[1,1,0] op_sel_hi:[0,1,1] neg_lo:[1,0,0]
  v_cvt_pk_bf16_f32 v60, v36, -v37
  ds_write_b32 v34, v60 offset:29920
  v_pk_mul_f32 v[26:27], v[36:37], v[30:31] op_sel:[0,0] op_sel_hi:[1,0]
  v_pk_fma_f32 v[36:37], v[36:37], v[30:31], v[26:27] op_sel:[1,1,0] op_sel_hi:[0,1,1] neg_lo:[1,0,0]
  v_cvt_pk_bf16_f32 v62, v36, -v37
  ds_write_b32 v34, v62 offset:30464
  s_branch L_KG2
L_KG1:
  v_pk_mul_f32 v[26:27], v[28:29], v[28:29] op_sel:[0,0] op_sel_hi:[1,0]
  v_pk_fma_f32 v[36:37], v[28:29], v[28:29], v[26:27] op_sel:[1,1,0] op_sel_hi:[0,1,1] neg_lo:[1,0,0]
  v_pk_mul_f32 v[58:59], v[32:33], v[32:33] op_sel:[0,0] op_sel_hi:[1,0]
  v_pk_fma_f32 v[38:39], v[32:33], v[32:33], v[58:59] op_sel:[1,1,0] op_sel_hi:[0,1,1] neg_lo:[1,0,0]
  v_pk_mul_f32 v[26:27], v[24:25], v[36:37] op_sel:[0,0] op_sel_hi:[1,0]
  v_pk_fma_f32 v[44:45], v[24:25], v[36:37], v[26:27] op_sel:[1,1,0] op_sel_hi:[0,1,1] neg_lo:[1,0,0]
  v_pk_mul_f32 v[58:59], v[38:39], v[32:33] op_sel:[0,0] op_sel_hi:[1,0]
  v_pk_fma_f32 v[40:41], v[38:39], v[32:33], v[58:59] op_sel:[1,1,0] op_sel_hi:[0,1,1] neg_lo:[1,0,0]
  v_pk_mul_f32 v[26:27], v[44:45], v[36:37] op_sel:[0,0] op_sel_hi:[1,0]
  v_pk_fma_f32 v[46:47], v[44:45], v[36:37], v[26:27] op_sel:[1,1,0] op_sel_hi:[0,1,1] neg_lo:[1,0,0]
  v_pk_mul_f32 v[58:59], v[38:39], v[38:39] op_sel:[0,0] op_sel_hi:[1,0]
  v_pk_fma_f32 v[42:43], v[38:39], v[38:39], v[58:59] op_sel:[1,1,0] op_sel_hi:[0,1,1] neg_lo:[1,0,0]
  v_pk_mul_f32 v[26:27], v[46:47], v[36:37] op_sel:[0,0] op_sel_hi:[1,0]
  v_pk_fma_f32 v[48:49], v[46:47], v[36:37], v[26:27] op_sel:[1,1,0] op_sel_hi:[0,1,1] neg_lo:[1,0,0]
  v_pk_mul_f32 v[58:59], v[24:25], v[42:43] op_sel:[0,0] op_sel_hi:[1,0]
  v_pk_fma_f32 v[50:51], v[24:25], v[42:43], v[58:59] op_sel:[1,1,0] op_sel_hi:[0,1,1] neg_lo:[1,0,0]
  v_cvt_pk_bf16_f32 v63, v50, v51
  ds_write_b32 v34, v63 offset:13056
  v_pk_mul_f32 v[26:27], v[46:47], v[42:43] op_sel:[0,0] op_sel_hi:[1,0]
  v_pk_fma_f32 v[56:57], v[46:47], v[42:43], v[26:27] op_sel:[1,1,0] op_sel_hi:[0,1,1] neg_lo:[1,0,0]
  v_cvt_pk_bf16_f32 v35, v56, v57
  ds_write_b32 v34, v35 offset:15232
  v_pk_mul_f32 v[58:59], v[50:51], v[32:33] op_sel:[0,0] op_sel_hi:[1,0]
  v_pk_fma_f32 v[50:51], v[50:51], v[32:33], v[58:59] op_sel:[1,1,0] op_sel_hi:[0,1,1] neg_lo:[1,0,0]
  v_cvt_pk_bf16_f32 v60, v50, v51
  ds_write_b32 v34, v60 offset:13600
  v_pk_mul_f32 v[26:27], v[56:57], v[32:33] op_sel:[0,0] op_sel_hi:[1,0]
  v_pk_fma_f32 v[56:57], v[56:57], v[32:33], v[26:27] op_sel:[1,1,0] op_sel_hi:[0,1,1] neg_lo:[1,0,0]
  v_cvt_pk_bf16_f32 v62, v56, v57
  ds_write_b32 v34, v62 offset:15776
  v_pk_mul_f32 v[58:59], v[50:51], v[32:33] op_sel:[0,0] op_sel_hi:[1,0]
  v_pk_fma_f32 v[50:51], v[50:51], v[32:33], v[58:59] op_sel:[1,1,0] op_sel_hi:[0,1,1] neg_lo:[1,0,0]
  v_cvt_pk_bf16_f32 v63, v50, v51
  ds_write_b32 v34, v63 offset:14144
  v_pk_mul_f32 v[26:27], v[56:57], v[32:33] op_sel:[0,0] op_sel_hi:[1,0]
  v_pk_fma_f32 v[56:57], v[56:57], v[32:33], v[26:27] op_sel:[1,1,0] op_sel_hi:[0,1,1] neg_lo:[1,0,0]
  v_cvt_pk_bf16_f32 v35, v56, v57
  ds_write_b32 v34, v35 offset:16320
  v_pk_mul_f32 v[58:59], v[50:51], v[32:33] op_sel:[0,0] op_sel_hi:[1,0]
  v_pk_fma_f32 v[50:51], v[50:51], v[32:33], v[58:59] op_sel:[1,1,0] op_sel_hi:[0,1,1] neg_lo:[1,0,0]
  v_cvt_pk_bf16_f32 v60, v50, v51
  ds_write_b32 v34, v60 offset:14688
  v_pk_mul_f32 v[26:27], v[56:57], v[32:33] op_sel:[0,0] op_sel_hi:[1,0]
  v_pk_fma_f32 v[56:57], v[56:57], v[32:33], v[26:27] op_sel:[1,1,0] op_sel_hi:[0,1,1] neg_lo:[1,0,0]
  v_cvt_pk_bf16_f32 v62, v56, v57
  ds_write_b32 v34, v62 offset:16864
  v_pk_mul_f32 v[58:59], v[50:51], v[32:33] op_sel:[0,0] op_sel_hi:[1,0]
  v_pk_fma_f32 v[50:51], v[50:51], v[32:33], v[58:59] op_sel:[1,1,0] op_sel_hi:[0,1,1] neg_lo:[1,0,0]
  v_cvt_pk_bf16_f32 v63, v50, v51
  ds_write_b32 v34, v63 offset:17408
  v_pk_mul_f32 v[26:27], v[24:25], v[38:39] op_sel:[0,0] op_sel_hi:[1,0]
  v_pk_fma_f32 v[30:31], v[24:25], v[38:39], v[26:27] op_sel:[1,1,0] op_sel_hi:[0,1,1] neg_lo:[1,0,0]
  v_cvt_pk_bf16_f32 v35, v30, v31
  ds_write_b32 v34, v35 offset:8704
  v_pk_mul_f32 v[58:59], v[50:51], v[32:33] op_sel:[0,0] op_sel_hi:[1,0]
  v_pk_fma_f32 v[50:51], v[50:51], v[32:33], v[58:59] op_sel:[1,1,0] op_sel_hi:[0,1,1] neg_lo:[1,0,0]
  v_cvt_pk_bf16_f32 v60, v50, v51
  ds_write_b32 v34, v60 offset:17952
  v_pk_mul_f32 v[26:27], v[24:25], v[40:41] op_sel:[0,0] op_sel_hi:[1,0]
  v_pk_fma_f32 v[30:31], v[24:25], v[40:41], v[26:27] op_sel:[1,1,0] op_sel_hi:[0,1,1] neg_lo:[1,0,0]
  v_cvt_pk_bf16_f32 v62, v30, v31
  ds_write_b32 v34, v62 offset:10880
  v_pk_mul_f32 v[58:59], v[50:51], v[32:33] op_sel:[0,0] op_sel_hi:[1,0]
  v_pk_fma_f32 v[50:51], v[50:51], v[32:33], v[58:59] op_sel:[1,1,0] op_sel_hi:[0,1,1] neg_lo:[1,0,0]
  v_cvt_pk_bf16_f32 v63, v50, v51
  ds_write_b32 v34, v63 offset:18496
  v_pk_mul_f32 v[26:27], v[44:45], v[38:39] op_sel:[0,0] op_sel_hi:[1,0]
  v_pk_fma_f32 v[30:31], v[44:45], v[38:39], v[26:27] op_sel:[1,1,0] op_sel_hi:[0,1,1] neg_lo:[1,0,0]
  v_cvt_pk_bf16_f32 v35, v30, v31
  ds_write_b32 v34, v35 offset:9248
  v_pk_mul_f32 v[58:59], v[50:51], v[32:33] op_sel:[0,0] op_sel_hi:[1,0]
  v_pk_fma_f32 v[50:51], v[50:51], v[32:33], v[58:59] op_sel:[1,1,0] op_sel_hi:[0,1,1] neg_lo:[1,0,0]
  v_cvt_pk_bf16_f32 v60, v50, v51
  ds_write_b32 v34, v60 offset:19040
  v_pk_mul_f32 v[26:27], v[44:45], v[40:41] op_sel:[0,0] op_sel_hi:[1,0]
  v_pk_fma_f32 v[30:31], v[44:45], v[40:41], v[26:27] op_sel:[1,1,0] op_sel_hi:[0,1,1] neg_lo:[1,0,0]
  v_cvt_pk_bf16_f32 v62, v30, v31
  ds_write_b32 v34, v62 offset:11424
  v_pk_mul_f32 v[58:59], v[50:51], v[32:33] op_sel:[0,0] op_sel_hi:[1,0]
  v_pk_fma_f32 v[50:51], v[50:51], v[32:33], v[58:59] op_sel:[1,1,0] op_sel_hi:[0,1,1] neg_lo:[1,0,0]
  v_cvt_pk_bf16_f32 v63, v50, v51
  ds_write_b32 v34, v63 offset:19584
  v_pk_mul_f32 v[26:27], v[46:47], v[38:39] op_sel:[0,0] op_sel_hi:[1,0]
  v_pk_fma_f32 v[30:31], v[46:47], v[38:39], v[26:27] op_sel:[1,1,0] op_sel_hi:[0,1,1] neg_lo:[1,0,0]
  v_cvt_pk_bf16_f32 v35, v30, v31
  ds_write_b32 v34, v35 offset:9792
  v_pk_mul_f32 v[58:59], v[50:51], v[32:33] op_sel:[0,0] op_sel_hi:[1,0]
  v_pk_fma_f32 v[50:51], v[50:51], v[32:33], v[58:59] op_sel:[1,1,0] op_sel_hi:[0,1,1] neg_lo:[1,0,0]
  v_cvt_pk_bf16_f32 v60, v50, v51
  ds_write_b32 v34, v60 offset:20128
  v_pk_mul_f32 v[26:27], v[46:47], v[40:41] op_sel:[0,0] op_sel_hi:[1,0]
  v_pk_fma_f32 v[30:31], v[46:47], v[40:41], v[26:27] op_sel:[1,1,0] op_sel_hi:[0,1,1] neg_lo:[1,0,0]
  v_cvt_pk_bf16_f32 v62, v30, v31
  ds_write_b32 v34, v62 offset:11968
  v_pk_mul_f32 v[58:59], v[50:51], v[32:33] op_sel:[0,0] op_sel_hi:[1,0]
  v_pk_fma_f32 v[50:51], v[50:51], v[32:33], v[58:59] op_sel:[1,1,0] op_sel_hi:[0,1,1] neg_lo:[1,0,0]
  v_cvt_pk_bf16_f32 v63, v50, v51
  ds_write_b32 v34, v63 offset:20672
  v_pk_mul_f32 v[26:27], v[48:49], v[38:39] op_sel:[0,0] op_sel_hi:[1,0]
  v_pk_fma_f32 v[30:31], v[48:49], v[38:39], v[26:27] op_sel:[1,1,0] op_sel_hi:[0,1,1] neg_lo:[1,0,0]
  v_cvt_pk_bf16_f32 v35, v30, v31
  ds_write_b32 v34, v35 offset:10336
  v_pk_mul_f32 v[58:59], v[50:51], v[32:33] op_sel:[0,0] op_sel_hi:[1,0]
  v_pk_fma_f32 v[50:51], v[50:51], v[32:33], v[58:59] op_sel:[1,1,0] op_sel_hi:[0,1,1] neg_lo:[1,0,0]
  v_cvt_pk_bf16_f32 v60, v50, v51
  ds_write_b32 v34, v60 offset:21216
  v_pk_mul_f32 v[26:27], v[48:49], v[40:41] op_sel:[0,0] op_sel_hi:[1,0]
  v_pk_fma_f32 v[30:31], v[48:49], v[40:41], v[26:27] op_sel:[1,1,0] op_sel_hi:[0,1,1] neg_lo:[1,0,0]
  v_cvt_pk_bf16_f32 v62, v30, v31
  ds_write_b32 v34, v62 offset:12512
  v_pk_mul_f32 v[58:59], v[50:51], v[32:33] op_sel:[0,0] op_sel_hi:[1,0]
  v_pk_fma_f32 v[50:51], v[50:51], v[32:33], v[58:59] op_sel:[1,1,0] op_sel_hi:[0,1,1] neg_lo:[1,0,0]
  v_cvt_pk_bf16_f32 v63, v50, v51
  ds_write_b32 v34, v63 offset:21760
L_KG2:
  s_and_b32 s50, s42, 3
  s_waitcnt lgkmcnt(0)
  s_barrier
  global_load_dwordx4 v[140:143], v160, s[40:41] sc1
  global_load_dwordx4 v[144:147], v160, s[40:41] offset:16 sc1
  global_load_dwordx2 v[148:149], v161, s[40:41] sc1
  global_load_dwordx2 v[154:155], v167, s[40:41] sc1
  s_mul_i32 s55, s2, 28672
  s_add_u32 s55, s55, 2097152
  v_lshlrev_b32 v64, 4, v0
  v_add_u32 v64, s55, v64
  v_lshlrev_b32 v65, 3, v0
  s_add_u32 s55, s55, 24576
  v_add_u32 v65, s55, v65
  global_store_dwordx4 v64, v[52:55], s[40:41] sc1
  v_add_u32 v64, 8192, v64
  global_store_dwordx4 v64, v[52:55], s[40:41] sc1
  v_add_u32 v64, 8192, v64
  global_store_dwordx4 v64, v[52:55], s[40:41] sc1
  global_store_dwordx2 v65, v[52:53], s[40:41] sc1
  s_cmp_eq_u32 s50, 3
  s_cbranch_scc1 L_KM_DONE
  ds_read_b128 v[192:195], v177 offset:0
  ds_read_b128 v[196:199], v176 offset:22304
  ds_read_b128 v[200:203], v177 offset:64
  ds_read_b128 v[204:207], v176 offset:22368
  ds_read_b128 v[208:211], v177 offset:128
  ds_read_b128 v[212:215], v176 offset:22432
  ds_read_b128 v[216:219], v177 offset:192
  ds_read_b128 v[220:223], v176 offset:22496
  ds_read_b128 v[224:227], v177 offset:256
  ds_read_b128 v[228:231], v176 offset:22560
  ds_read_b128 v[232:235], v177 offset:320
  ds_read_b128 v[236:239], v176 offset:22624
  ds_read_b128 v[240:243], v177 offset:384
  ds_read_b128 v[244:247], v176 offset:22688
  ds_read_b128 v[248:251], v177 offset:448
  ds_read_b128 v[252:255], v176 offset:22752
  s_waitcnt lgkmcnt(14)
  v_mfma_f32_16x16x32_bf16 v[40:43], v[192:195], v[196:199], 0
  s_waitcnt lgkmcnt(12)
  v_mfma_f32_16x16x32_bf16 v[56:59], v[200:203], v[204:207], 0
  s_waitcnt lgkmcnt(10)
  v_mfma_f32_16x16x32_bf16 v[40:43], v[208:211], v[212:215], v[40:43]
  s_waitcnt lgkmcnt(8)
  v_mfma_f32_16x16x32_bf16 v[56:59], v[216:219], v[220:223], v[56:59]
  s_waitcnt lgkmcnt(6)
  v_mfma_f32_16x16x32_bf16 v[40:43], v[224:227], v[228:231], v[40:43]
  s_waitcnt lgkmcnt(4)
  v_mfma_f32_16x16x32_bf16 v[56:59], v[232:235], v[236:239], v[56:59]
  s_waitcnt lgkmcnt(2)
  v_mfma_f32_16x16x32_bf16 v[40:43], v[240:243], v[244:247], v[40:43]
  s_waitcnt lgkmcnt(0)
  v_mfma_f32_16x16x32_bf16 v[56:59], v[248:251], v[252:255], v[56:59]
  s_nop 7
  v_add_f32 v40, v40, v56
  v_add_f32 v41, v41, v57
  v_add_f32 v42, v42, v58
  v_add_f32 v43, v43, v59
  ds_write_b32 v178, v40
  ds_write_b32 v179, v41
  ds_write_b32 v180, v42
  ds_write_b32 v181, v43
L_KM_DONE:
  s_waitcnt lgkmcnt(0)
  s_barrier
  s_cmp_eq_u32 s42, 2
  s_cbranch_scc0 L_ZT1
  v_lshrrev_b32 v36, 2, v1
  v_mul_u32_u24 v36, 4160, v36
  v_and_b32 v37, 3, v1
  v_lshl_add_u32 v36, v37, 4, v36
  v_add_u32 v36, 21440, v36
  v_mov_b32 v40, 0
  v_mov_b32 v41, 0
  v_mov_b32 v42, 0
  v_mov_b32 v43, 0
  s_mov_b64 exec, 0xffffffff
  ds_write_b128 v36, v[40:43]
  s_mov_b64 exec, -1
  s_waitcnt lgkmcnt(0)
L_ZT1:
  s_waitcnt vmcnt(4)
  v_xor_b32 v36, v3, v141
  v_xor_b32 v37, v3, v143
  v_or_b32 v36, v36, v37
  v_xor_b32 v37, v3, v145
  v_or_b32 v36, v36, v37
  v_xor_b32 v37, v3, v147
  v_or_b32 v36, v36, v37
  v_xor_b32 v37, v3, v149
  v_or_b32 v36, v36, v37
  v_xor_b32 v37, v3, v154
  v_or_b32 v36, v36, v37
  v_xor_b32 v37, v3, v155
  v_or_b32 v36, v36, v37
  v_cmp_ne_u32 vcc, 0, v36
  s_mov_b32 s68, 0
  s_cbranch_vccnz L_XT_NO
  global_load_dwordx2 v[156:157], v163, s[40:41] sc1
  global_load_dwordx2 v[158:159], v172, s[40:41]  sc1
  s_mov_b32 s68, 1
L_XT_NO:
  ds_read_b32 v112, v100
  ds_read_b32 v113, v101
  ds_read_b32 v114, v102
  ds_read_b32 v115, v103
  ds_read_b32 v116, v104
  ds_read_b32 v117, v105
  ds_read_b32 v118, v106
  ds_read_b32 v119, v107
  ds_read_b32 v120, v108
  ds_read_b32 v121, v109
  ds_read_b32 v122, v110
  s_waitcnt lgkmcnt(3)
  v_cvt_pk_bf16_f32 v124, v112, v113
  v_cvt_pk_bf16_f32 v125, v114, v115
  v_cvt_pk_bf16_f32 v126, v116, v117
  v_cvt_pk_bf16_f32 v127, v118, v119
  ds_write_b128 v111, v[124:127] offset:0
  s_waitcnt lgkmcnt(3)
  v_cvt_pk_bf16_f32 v128, v113, v114
  v_cvt_pk_bf16_f32 v129, v115, v116
  v_cvt_pk_bf16_f32 v130, v117, v118
  v_cvt_pk_bf16_f32 v131, v119, v120
  ds_write_b128 v111, v[128:131] offset:4160
  s_waitcnt lgkmcnt(3)
  v_cvt_pk_bf16_f32 v132, v114, v115
  v_cvt_pk_bf16_f32 v133, v116, v117
  v_cvt_pk_bf16_f32 v134, v118, v119
  v_cvt_pk_bf16_f32 v135, v120, v121
  ds_write_b128 v111, v[132:135] offset:8320
  s_waitcnt lgkmcnt(3)
  v_cvt_pk_bf16_f32 v136, v115, v116
  v_cvt_pk_bf16_f32 v137, v117, v118
  v_cvt_pk_bf16_f32 v138, v119, v120
  v_cvt_pk_bf16_f32 v139, v121, v122
  ds_write_b128 v111, v[136:139] offset:12480
  s_cmp_eq_u32 s68, 1
  s_cbranch_scc1 L_PB_DONE
  s_mov_b32 s60, 0
L_PB:
  global_load_dwordx4 v[140:143], v160, s[40:41] sc1
  global_load_dwordx4 v[144:147], v160, s[40:41] offset:16 sc1
  global_load_dwordx2 v[148:149], v161, s[40:41] sc1
  global_load_dwordx2 v[154:155], v167, s[40:41] sc1
  s_waitcnt vmcnt(0)
  v_xor_b32 v38, v3, v141
  v_xor_b32 v39, v3, v143
  v_or_b32 v38, v38, v39
  v_xor_b32 v39, v3, v145
  v_or_b32 v38, v38, v39
  v_xor_b32 v39, v3, v147
  v_or_b32 v38, v38, v39
  v_xor_b32 v39, v3, v149
  v_or_b32 v38, v38, v39
  v_xor_b32 v39, v3, v154
  v_or_b32 v38, v38, v39
  v_xor_b32 v39, v3, v155
  v_or_b32 v38, v38, v39
  v_cmp_ne_u32 vcc, 0, v38
  s_add_u32 s60, s60, 1
  s_cmp_gt_u32 s60, 200000
  s_cbranch_scc1 L_PB_X
  s_cbranch_vccnz L_PB
L_PB_X:
  global_load_dwordx2 v[156:157], v163, s[40:41] sc1
  global_load_dwordx2 v[158:159], v172, s[40:41]  sc1
L_PB_DONE:
  s_lshl_b32 s55, s42, 12
  v_xor_b32 v2, 0, v175
  v_add_u32 v2, 0, v2
  s_add_u32 m0, s55, 131072
  s_nop 0
  global_load_lds_dwordx4 v2, s[26:27]
  v_xor_b32 v2, 32, v175
  v_add_u32 v2, 8192, v2
  s_add_u32 m0, s55, 132096
  s_nop 0
  global_load_lds_dwordx4 v2, s[26:27]
  v_xor_b32 v2, 64, v175
  v_add_u32 v2, 16384, v2
  s_add_u32 m0, s55, 133120
  s_nop 0
  global_load_lds_dwordx4 v2, s[26:27]
  v_xor_b32 v2, 96, v175
  v_add_u32 v2, 24576, v2
  s_add_u32 m0, s55, 134144
  s_nop 0
  global_load_lds_dwordx4 v2, s[26:27]
  v_add_f32_dpp v148, v148, v148 quad_perm:[1,0,3,2] row_mask:0xf bank_mask:0xf
  s_nop 1
  v_add_f32_dpp v148, v148, v148 quad_perm:[2,3,0,1] row_mask:0xf bank_mask:0xf
  v_cvt_pk_bf16_f32 v148, v148, v148
  v_and_b32 v148, 0xffff0000, v148
  s_nop 0
  v_readlane_b32 s50, v148, 0
  s_nop 1
  v_mov_b32 v60, s50
  v_readlane_b32 s50, v148, 4
  s_nop 1
  v_mov_b32 v61, s50
  v_readlane_b32 s50, v148, 8
  s_nop 1
  v_mov_b32 v62, s50
  v_readlane_b32 s50, v148, 12
  s_nop 1
  v_mov_b32 v63, s50
  v_readlane_b32 s50, v148, 16
  s_nop 1
  v_mov_b32 v150, s50
  v_readlane_b32 s50, v148, 20
  s_nop 1
  v_mov_b32 v151, s50
  v_add_f32 v62, 1.0, v62
  v_add_f32 v63, 1.0, v63
  v_cvt_pk_bf16_f32 v38, v62, v63
  v_lshlrev_b32 v62, 16, v38
  v_and_b32 v63, 0xffff0000, v38
  v_and_b32 v80, 0xffff0000, v140
  v_lshlrev_b32 v84, 16, v140
  v_and_b32 v81, 0xffff0000, v142
  v_lshlrev_b32 v85, 16, v142
  v_and_b32 v82, 0xffff0000, v144
  v_lshlrev_b32 v86, 16, v144
  v_and_b32 v83, 0xffff0000, v146
  v_lshlrev_b32 v87, 16, v146
  v_rcp_f32 v80, v80
  v_rcp_f32 v81, v81
  v_rcp_f32 v82, v82
  v_rcp_f32 v83, v83
  s_waitcnt vmcnt(4)
  v_lshlrev_b32 v88, 16, v156
  v_and_b32 v90, 0xffff0000, v156
  v_lshlrev_b32 v92, 16, v157
  v_and_b32 v94, 0xffff0000, v157
  v_lshlrev_b32 v89, 16, v158
  v_and_b32 v91, 0xffff0000, v158
  v_lshlrev_b32 v93, 16, v159
  v_and_b32 v95, 0xffff0000, v159
  v_lshlrev_b32 v56, 3, v0
  ds_write_b64 v56, v[156:157] offset:0
  ds_write_b64 v56, v[158:159] offset:4096
  v_sub_f32 v88, v88, v84
  v_sub_f32 v89, v89, v84
  v_sub_f32 v90, v90, v85
  v_sub_f32 v91, v91, v85
  v_sub_f32 v92, v92, v86
  v_sub_f32 v93, v93, v86
  v_sub_f32 v94, v94, v87
  v_sub_f32 v95, v95, v87
  v_cvt_pk_bf16_f32 v96, v88, v89
  v_cvt_pk_bf16_f32 v97, v90, v91
  v_cvt_pk_bf16_f32 v98, v92, v93
  v_cvt_pk_bf16_f32 v99, v94, v95
  v_lshlrev_b32 v88, 16, v96
  v_and_b32 v89, 0xffff0000, v96
  v_lshlrev_b32 v90, 16, v97
  v_and_b32 v91, 0xffff0000, v97
  v_lshlrev_b32 v92, 16, v98
  v_and_b32 v93, 0xffff0000, v98
  v_lshlrev_b32 v94, 16, v99
  v_and_b32 v95, 0xffff0000, v99
  v_mul_f32 v88, v88, v80
  v_mul_f32 v89, v89, v80
  v_mul_f32 v90, v90, v81
  v_mul_f32 v91, v91, v81
  v_mul_f32 v92, v92, v82
  v_mul_f32 v93, v93, v82
  v_mul_f32 v94, v94, v83
  v_mul_f32 v95, v95, v83
  v_cvt_pk_bf16_f32 v96, v88, v89
  v_cvt_pk_bf16_f32 v97, v90, v91
  v_cvt_pk_bf16_f32 v98, v92, v93
  v_cvt_pk_bf16_f32 v99, v94, v95
  v_lshlrev_b32 v88, 16, v96
  v_and_b32 v89, 0xffff0000, v96
  v_lshlrev_b32 v90, 16, v97
  v_and_b32 v91, 0xffff0000, v97
  v_lshlrev_b32 v92, 16, v98
  v_and_b32 v93, 0xffff0000, v98
  v_lshlrev_b32 v94, 16, v99
  v_and_b32 v95, 0xffff0000, v99
  v_mul_f32 v88, v88, v62
  v_mul_f32 v89, v89, v63
  v_mul_f32 v90, v90, v62
  v_mul_f32 v91, v91, v63
  v_mul_f32 v92, v92, v62
  v_mul_f32 v93, v93, v63
  v_mul_f32 v94, v94, v62
  v_mul_f32 v95, v95, v63
  v_cvt_pk_bf16_f32 v96, v88, v89
  v_cvt_pk_bf16_f32 v97, v90, v91
  v_cvt_pk_bf16_f32 v98, v92, v93
  v_cvt_pk_bf16_f32 v99, v94, v95
  v_lshlrev_b32 v88, 16, v96
  v_and_b32 v89, 0xffff0000, v96
  v_lshlrev_b32 v90, 16, v97
  v_and_b32 v91, 0xffff0000, v97
  v_lshlrev_b32 v92, 16, v98
  v_and_b32 v93, 0xffff0000, v98
  v_lshlrev_b32 v94, 16, v99
  v_and_b32 v95, 0xffff0000, v99
  v_add_f32 v88, v88, v60
  v_add_f32 v89, v89, v61
  v_add_f32 v90, v90, v60
  v_add_f32 v91, v91, v61
  v_add_f32 v92, v92, v60
  v_add_f32 v93, v93, v61
  v_add_f32 v94, v94, v60
  v_add_f32 v95, v95, v61
  v_cvt_pk_bf16_f32 v100, v88, v90
  v_cvt_pk_bf16_f32 v101, v92, v94
  v_cvt_pk_bf16_f32 v102, v89, v91
  v_cvt_pk_bf16_f32 v103, v93, v95
  ds_write_b64 v164, v[100:101]
  ds_write_b64 v164, v[102:103] offset:4576
  s_cmp_eq_u32 s53, 0
  s_cbranch_scc1 L_GA0
  v_mov_b32 v14, v151
  s_branch L_GA1
L_GA0:
  v_mov_b32 v14, v150
L_GA1:
  v_lshlrev_b32 v15, 16, v23
  v_readfirstlane_b32 s66, v14
  v_readfirstlane_b32 s67, v15
  s_waitcnt lgkmcnt(0)
  s_barrier
  v_mov_b32 v5, v168
  v_mov_b32 v6, v169
  v_mov_b32 v7, v170
  v_mov_b32 v8, v171
  v_mov_b32 v9, v174
  s_add_u32 s50, s46, 8
  s_mul_i32 s50, s50, 7
  s_min_u32 s51, s42, 6
  s_add_u32 s50, s50, s51
  s_lshl_b32 s50, s50, 14
  s_add_u32 s50, s50, 9437184
  v_lshlrev_b32 v13, 4, v1
  v_add_u32 v13, s50, v13
  v_subrev_u32 v14, 64, v165
  v_subrev_u32 v15, 64, v166
  ds_read_b128 v[64:67], v15 offset:64
  ds_read_b64 v[32:33], v14 offset:3648
  ds_read_b64 v[34:35], v14 offset:3656
  ds_read_b128 v[68:71], v15 offset:576
  ds_read_b64 v[36:37], v14 offset:3136
  ds_read_b64 v[38:39], v14 offset:3144
  ds_read_b128 v[72:75], v15 offset:1088
  ds_read_b64 v[40:41], v14 offset:2624
  ds_read_b64 v[42:43], v14 offset:2632
  ds_read_b128 v[76:79], v15 offset:1600
  ds_read_b64 v[44:45], v14 offset:2112
  ds_read_b64 v[46:47], v14 offset:2120
  ds_read_b128 v[80:83], v15 offset:2112
  ds_read_b64 v[48:49], v14 offset:1600
  ds_read_b64 v[50:51], v14 offset:1608
  ds_read_b128 v[84:87], v15 offset:2624
  ds_read_b64 v[52:53], v14 offset:1088
  ds_read_b64 v[54:55], v14 offset:1096
  ds_read_b128 v[88:91], v15 offset:3136
  ds_read_b64 v[56:57], v14 offset:576
  ds_read_b64 v[58:59], v14 offset:584
  ds_read_b128 v[92:95], v15 offset:3648
  ds_read_b64 v[60:61], v14 offset:64
  ds_read_b64 v[62:63], v14 offset:72
  s_waitcnt lgkmcnt(0)
  v_mfma_f32_16x16x32_bf16 v[160:163], v[32:35], v[64:67], 0
  ds_read_b128 v[128:131], v15 offset:0
  v_mfma_f32_16x16x32_bf16 v[164:167], v[32:35], v[68:71], 0
  ds_read_b64 v[96:97], v14 offset:3584
  v_mfma_f32_16x16x32_bf16 v[164:167], v[36:39], v[64:67], v[164:167]
  ds_read_b64 v[98:99], v14 offset:3592
  v_mfma_f32_16x16x32_bf16 v[168:171], v[36:39], v[68:71], 0
  ds_read_b128 v[132:135], v15 offset:512
  global_load_dwordx4 v[192:195], v13, s[40:41] offset:0 sc1
  v_mfma_f32_16x16x32_bf16 v[168:171], v[32:35], v[72:75], v[168:171]
  ds_read_b64 v[100:101], v14 offset:3072
  v_mfma_f32_16x16x32_bf16 v[168:171], v[40:43], v[64:67], v[168:171]
  ds_read_b64 v[102:103], v14 offset:3080
  v_mfma_f32_16x16x32_bf16 v[172:175], v[36:39], v[72:75], 0
  ds_read_b128 v[136:139], v15 offset:1024
  v_mfma_f32_16x16x32_bf16 v[172:175], v[40:43], v[68:71], v[172:175]
  ds_read_b64 v[104:105], v14 offset:2560
  global_load_dwordx4 v[196:199], v13, s[40:41] offset:1024 sc1
  v_mfma_f32_16x16x32_bf16 v[176:179], v[40:43], v[72:75], 0
  ds_read_b64 v[106:107], v14 offset:2568
  v_mfma_f32_16x16x32_bf16 v[172:175], v[32:35], v[76:79], v[172:175]
  ds_read_b128 v[140:143], v15 offset:1536
  v_mfma_f32_16x16x32_bf16 v[172:175], v[44:47], v[64:67], v[172:175]
  ds_read_b64 v[108:109], v14 offset:2048
  v_mfma_f32_16x16x32_bf16 v[176:179], v[36:39], v[76:79], v[176:179]
  ds_read_b64 v[110:111], v14 offset:2056
  global_load_dwordx4 v[200:203], v13, s[40:41] offset:2048 sc1
  v_mfma_f32_16x16x32_bf16 v[176:179], v[44:47], v[68:71], v[176:179]
  ds_read_b128 v[144:147], v15 offset:2048
  v_mfma_f32_16x16x32_bf16 v[180:183], v[40:43], v[76:79], 0
  ds_read_b64 v[112:113], v14 offset:1536
  v_mfma_f32_16x16x32_bf16 v[180:183], v[44:47], v[72:75], v[180:183]
  ds_read_b64 v[114:115], v14 offset:1544
  v_mfma_f32_16x16x32_bf16 v[184:187], v[44:47], v[76:79], 0
  ds_read_b128 v[148:151], v15 offset:2560
  global_load_dwordx4 v[204:207], v13, s[40:41] offset:3072 sc1
  v_add_u32 v13, 4096, v13
  v_mfma_f32_16x16x32_bf16 v[176:179], v[32:35], v[80:83], v[176:179]
  ds_read_b64 v[116:117], v14 offset:1024
  v_mfma_f32_16x16x32_bf16 v[176:179], v[48:51], v[64:67], v[176:179]
  ds_read_b64 v[118:119], v14 offset:1032
  v_mfma_f32_16x16x32_bf16 v[180:183], v[36:39], v[80:83], v[180:183]
  ds_read_b128 v[152:155], v15 offset:3072
  v_mfma_f32_16x16x32_bf16 v[180:183], v[48:51], v[68:71], v[180:183]
  ds_read_b64 v[120:121], v14 offset:512
  global_load_dwordx4 v[208:211], v13, s[40:41] offset:0 sc1
  v_mfma_f32_16x16x32_bf16 v[184:187], v[40:43], v[80:83], v[184:187]
  ds_read_b64 v[122:123], v14 offset:520
  v_mfma_f32_16x16x32_bf16 v[184:187], v[48:51], v[72:75], v[184:187]
  ds_read_b128 v[156:159], v15 offset:3584
  v_mfma_f32_16x16x32_bf16 v[188:191], v[44:47], v[80:83], 0
  ds_read_b64 v[124:125], v14 offset:0
  v_mfma_f32_16x16x32_bf16 v[188:191], v[48:51], v[76:79], v[188:191]
  ds_read_b64 v[126:127], v14 offset:8
  global_load_dwordx4 v[212:215], v13, s[40:41] offset:1024 sc1
  v_mfma_f32_16x16x32_bf16 v[180:183], v[32:35], v[84:87], v[180:183]
  v_mfma_f32_16x16x32_bf16 v[180:183], v[52:55], v[64:67], v[180:183]
  v_mfma_f32_16x16x32_bf16 v[184:187], v[36:39], v[84:87], v[184:187]
  v_mfma_f32_16x16x32_bf16 v[184:187], v[52:55], v[68:71], v[184:187]
  global_load_dwordx4 v[216:219], v13, s[40:41] offset:2048 sc1
  v_mfma_f32_16x16x32_bf16 v[188:191], v[40:43], v[84:87], v[188:191]
  v_mfma_f32_16x16x32_bf16 v[188:191], v[52:55], v[72:75], v[188:191]
  v_mfma_f32_16x16x32_bf16 v[184:187], v[32:35], v[88:91], v[184:187]
  v_mfma_f32_16x16x32_bf16 v[184:187], v[56:59], v[64:67], v[184:187]
  global_load_dwordx4 v[220:223], v13, s[40:41] offset:3072 sc1
  v_add_u32 v13, 4096, v13
  v_mfma_f32_16x16x32_bf16 v[188:191], v[36:39], v[88:91], v[188:191]
  v_mfma_f32_16x16x32_bf16 v[188:191], v[56:59], v[68:71], v[188:191]
  v_mfma_f32_16x16x32_bf16 v[188:191], v[32:35], v[92:95], v[188:191]
  v_mfma_f32_16x16x32_bf16 v[188:191], v[60:63], v[64:67], v[188:191]
  global_load_dwordx4 v[224:227], v13, s[40:41] offset:0 sc1
  s_waitcnt vmcnt(9)
  s_barrier
  s_waitcnt lgkmcnt(0)
  v_mfma_f32_16x16x32_bf16 v[160:163], v[96:99], v[128:131], v[160:163]
  ds_read_b128 v[16:19], v5
  ds_read_b128 v[20:23], v6
  ds_read_b128 v[24:27], v7
  ds_read_b128 v[28:31], v8
  v_mfma_f32_16x16x32_bf16 v[164:167], v[96:99], v[132:135], v[164:167]
  v_mfma_f32_16x16x32_bf16 v[164:167], v[100:103], v[128:131], v[164:167]
  v_mfma_f32_16x16x32_bf16 v[168:171], v[100:103], v[132:135], v[168:171]
  global_load_dwordx4 v[228:231], v13, s[40:41] offset:1024 sc1
  v_mfma_f32_16x16x32_bf16 v[168:171], v[96:99], v[136:139], v[168:171]
  v_mfma_f32_16x16x32_bf16 v[168:171], v[104:107], v[128:131], v[168:171]
  v_mfma_f32_16x16x32_bf16 v[172:175], v[100:103], v[136:139], v[172:175]
  v_mfma_f32_16x16x32_bf16 v[172:175], v[104:107], v[132:135], v[172:175]
  global_load_dwordx4 v[232:235], v13, s[40:41] offset:2048 sc1
  v_mfma_f32_16x16x32_bf16 v[176:179], v[104:107], v[136:139], v[176:179]
  v_mfma_f32_16x16x32_bf16 v[172:175], v[96:99], v[140:143], v[172:175]
  v_mfma_f32_16x16x32_bf16 v[172:175], v[108:111], v[128:131], v[172:175]
  v_mfma_f32_16x16x32_bf16 v[176:179], v[100:103], v[140:143], v[176:179]
  global_load_dwordx4 v[236:239], v13, s[40:41] offset:3072 sc1
  v_add_u32 v13, 4096, v13
  v_mfma_f32_16x16x32_bf16 v[176:179], v[108:111], v[132:135], v[176:179]
  s_waitcnt lgkmcnt(0)
  v_mfma_f32_16x16x32_bf16 v[180:183], v[104:107], v[140:143], v[180:183]
  global_store_dwordx4 v9, v[16:19], s[40:41] offset:0 sc1
  v_mfma_f32_16x16x32_bf16 v[180:183], v[108:111], v[136:139], v[180:183]
  v_mfma_f32_16x16x32_bf16 v[184:187], v[108:111], v[140:143], v[184:187]
  global_load_dwordx4 v[240:243], v13, s[40:41] offset:0 sc1
  v_mfma_f32_16x16x32_bf16 v[176:179], v[96:99], v[144:147], v[176:179]
  v_mfma_f32_16x16x32_bf16 v[176:179], v[112:115], v[128:131], v[176:179]
  global_store_dwordx4 v9, v[20:23], s[40:41] offset:1024 sc1
  v_mfma_f32_16x16x32_bf16 v[180:183], v[100:103], v[144:147], v[180:183]
  v_mfma_f32_16x16x32_bf16 v[180:183], v[112:115], v[132:135], v[180:183]
  global_load_dwordx4 v[244:247], v13, s[40:41] offset:1024 sc1
  v_mfma_f32_16x16x32_bf16 v[184:187], v[104:107], v[144:147], v[184:187]
  v_mfma_f32_16x16x32_bf16 v[184:187], v[112:115], v[136:139], v[184:187]
  global_store_dwordx4 v9, v[24:27], s[40:41] offset:2048 sc1
  v_mfma_f32_16x16x32_bf16 v[188:191], v[108:111], v[144:147], v[188:191]
  v_mfma_f32_16x16x32_bf16 v[188:191], v[112:115], v[140:143], v[188:191]
  global_load_dwordx4 v[248:251], v13, s[40:41] offset:2048 sc1
  v_mfma_f32_16x16x32_bf16 v[180:183], v[96:99], v[148:151], v[180:183]
  v_mfma_f32_16x16x32_bf16 v[180:183], v[116:119], v[128:131], v[180:183]
  global_store_dwordx4 v9, v[28:31], s[40:41] offset:3072 sc1
  v_mfma_f32_16x16x32_bf16 v[184:187], v[100:103], v[148:151], v[184:187]
  v_mfma_f32_16x16x32_bf16 v[184:187], v[116:119], v[132:135], v[184:187]
  global_load_dwordx4 v[252:255], v13, s[40:41] offset:3072 sc1
  v_mfma_f32_16x16x32_bf16 v[188:191], v[104:107], v[148:151], v[188:191]
  v_mfma_f32_16x16x32_bf16 v[188:191], v[116:119], v[136:139], v[188:191]
  v_mfma_f32_16x16x32_bf16 v[184:187], v[96:99], v[152:155], v[184:187]
  v_mfma_f32_16x16x32_bf16 v[184:187], v[120:123], v[128:131], v[184:187]
  v_mfma_f32_16x16x32_bf16 v[188:191], v[100:103], v[152:155], v[188:191]
  v_mfma_f32_16x16x32_bf16 v[188:191], v[120:123], v[132:135], v[188:191]
  v_mfma_f32_16x16x32_bf16 v[188:191], v[96:99], v[156:159], v[188:191]
  v_mfma_f32_16x16x32_bf16 v[188:191], v[124:127], v[128:131], v[188:191]
  v_lshlrev_b32 v12, 4, v1
  s_lshl_b32 s50, s53, 15
  s_and_b32 s51, s42, 3
  s_lshl_b32 s55, s51, 10
  s_add_u32 s50, s50, s55
  s_add_u32 s50, s50, 53248
  v_add_u32 v13, s50, v12
  s_lshl_b32 s50, s53, 15
  s_add_u32 s50, s50, 53248
  s_lshl_b32 s55, s51, 10
  s_add_u32 s50, s50, s55
  s_lshl_b32 s55, s51, 12
  s_add_u32 s58, s50, s55
  v_add_u32 v14, s58, v12
  s_sub_u32 s55, 7, s51
  s_lshl_b32 s55, s55, 12
  s_add_u32 s58, s50, s55
  v_add_u32 v15, s58, v12
  v_and_b32 v84, 15, v1
  v_lshrrev_b32 v85, 4, v1
  v_lshlrev_b32 v86, 4, v84
  v_lshl_add_u32 v86, v85, 2, v86
  s_lshl_b32 s50, s62, 8
  v_add_u32 v87, s50, v86
  v_lshlrev_b32 v87, 1, v87
  s_lshl_b32 s50, s53, 12
  v_add_u32 v88, s50, v87
  ds_read_b64 v[28:29], v88 offset:0
  s_mul_i32 s50, s53, 4576
  s_add_u32 s50, s50, 8672
  v_add_u32 v87, s50, v87
  ds_read_b64 v[24:25], v87
  s_lshl_b32 s50, s63, 8
  v_add_u32 v87, s50, v86
  v_lshlrev_b32 v87, 1, v87
  s_lshl_b32 s50, s53, 12
  v_add_u32 v88, s50, v87
  ds_read_b64 v[30:31], v88 offset:0
  s_mul_i32 s50, s53, 4576
  s_add_u32 s50, s50, 8672
  v_add_u32 v87, s50, v87
  ds_read_b64 v[26:27], v87
  v_lshlrev_b32 v87, 5, v84
  v_and_b32 v88, 2, v85
  v_lshl_add_u32 v87, v88, 3, v87
  s_lshl_b32 s50, s62, 9
  s_lshl_b32 s55, s63, 9
  s_sub_u32 s55, s55, s50
  v_and_b32 v88, 1, v85
  v_mul_i32_i24 v88, s55, v88
  v_add_u32 v87, v87, v88
  s_lshl_b32 s55, s52, 12
  s_add_u32 s50, s50, s55
  v_add_u32 v90, s50, v87
  v_mov_b32 v91, s66
  v_mov_b32 v92, s67
  s_nop 7
  s_cmp_eq_u32 s51, 0
  s_cbranch_scc0 L_XW1
  ds_write_b128 v13, v[164:167] offset:4096
  ds_write_b128 v13, v[168:171] offset:8192
  ds_write_b128 v13, v[172:175] offset:12288
  ds_write_b128 v13, v[176:179] offset:16384
  ds_write_b128 v13, v[180:183] offset:20480
  ds_write_b128 v13, v[184:187] offset:24576
  v_mov_b32 v32, v160
  v_mov_b32 v36, v188
  v_mov_b32 v33, v161
  v_mov_b32 v37, v189
  v_mov_b32 v34, v162
  v_mov_b32 v38, v190
  v_mov_b32 v35, v163
  v_mov_b32 v39, v191
  s_branch L_XWD
L_XW1:
  s_cmp_eq_u32 s51, 1
  s_cbranch_scc0 L_XW2
  ds_write_b128 v13, v[160:163] offset:0
  ds_write_b128 v13, v[168:171] offset:8192
  ds_write_b128 v13, v[172:175] offset:12288
  ds_write_b128 v13, v[176:179] offset:16384
  ds_write_b128 v13, v[180:183] offset:20480
  ds_write_b128 v13, v[188:191] offset:28672
  v_mov_b32 v32, v164
  v_mov_b32 v36, v184
  v_mov_b32 v33, v165
  v_mov_b32 v37, v185
  v_mov_b32 v34, v166
  v_mov_b32 v38, v186
  v_mov_b32 v35, v167
  v_mov_b32 v39, v187
  s_branch L_XWD
L_XW2:
  s_cmp_eq_u32 s51, 2
  s_cbranch_scc0 L_XW3
  ds_write_b128 v13, v[160:163] offset:0
  ds_write_b128 v13, v[164:167] offset:4096
  ds_write_b128 v13, v[172:175] offset:12288
  ds_write_b128 v13, v[176:179] offset:16384
  ds_write_b128 v13, v[184:187] offset:24576
  ds_write_b128 v13, v[188:191] offset:28672
  v_mov_b32 v32, v168
  v_mov_b32 v36, v180
  v_mov_b32 v33, v169
  v_mov_b32 v37, v181
  v_mov_b32 v34, v170
  v_mov_b32 v38, v182
  v_mov_b32 v35, v171
  v_mov_b32 v39, v183
  s_branch L_XWD
L_XW3:
  ds_write_b128 v13, v[160:163] offset:0
  ds_write_b128 v13, v[164:167] offset:4096
  ds_write_b128 v13, v[168:171] offset:8192
  ds_write_b128 v13, v[180:183] offset:20480
  ds_write_b128 v13, v[184:187] offset:24576
  ds_write_b128 v13, v[188:191] offset:28672
  v_mov_b32 v32, v172
  v_mov_b32 v36, v176
  v_mov_b32 v33, v173
  v_mov_b32 v37, v177
  v_mov_b32 v34, v174
  v_mov_b32 v38, v178
  v_mov_b32 v35, v175
  v_mov_b32 v39, v179
L_XWD:
  s_waitcnt lgkmcnt(6)
  v_lshlrev_b32 v40, 16, v24
  v_and_b32 v41, 0xffff0000, v24
  v_lshlrev_b32 v42, 16, v25
  v_and_b32 v43, 0xffff0000, v25
  v_lshlrev_b32 v44, 16, v26
  v_and_b32 v45, 0xffff0000, v26
  v_lshlrev_b32 v46, 16, v27
  v_and_b32 v47, 0xffff0000, v27
  v_mul_f32 v40, v40, v92
  v_mul_f32 v41, v41, v92
  v_mul_f32 v42, v42, v92
  v_mul_f32 v43, v43, v92
  v_mul_f32 v44, v44, v92
  v_mul_f32 v45, v45, v92
  v_mul_f32 v46, v46, v92
  v_mul_f32 v47, v47, v92
  v_cvt_pk_bf16_f32 v24, v40, v41
  v_cvt_pk_bf16_f32 v25, v42, v43
  v_cvt_pk_bf16_f32 v26, v44, v45
  v_cvt_pk_bf16_f32 v27, v46, v47
  v_lshlrev_b32 v40, 16, v24
  v_and_b32 v41, 0xffff0000, v24
  v_lshlrev_b32 v42, 16, v25
  v_and_b32 v43, 0xffff0000, v25
  v_lshlrev_b32 v44, 16, v26
  v_and_b32 v45, 0xffff0000, v26
  v_lshlrev_b32 v46, 16, v27
  v_and_b32 v47, 0xffff0000, v27
  v_lshlrev_b32 v16, 16, v28
  v_and_b32 v17, 0xffff0000, v28
  v_lshlrev_b32 v18, 16, v29
  v_and_b32 v19, 0xffff0000, v29
  v_lshlrev_b32 v20, 16, v30
  v_and_b32 v21, 0xffff0000, v30
  v_lshlrev_b32 v22, 16, v31
  v_and_b32 v23, 0xffff0000, v31
  s_waitcnt lgkmcnt(0)
  s_barrier
  v_xor_b32 v2, 1024, v14
  ds_read_b128 v[60:63], v2
  v_xor_b32 v12, 1024, v15
  ds_read_b128 v[64:67], v12
  v_xor_b32 v2, 2048, v14
  ds_read_b128 v[68:71], v2
  v_xor_b32 v12, 2048, v15
  ds_read_b128 v[72:75], v12
  v_xor_b32 v2, 3072, v14
  ds_read_b128 v[76:79], v2
  v_xor_b32 v12, 3072, v15
  ds_read_b128 v[80:83], v12
  s_waitcnt lgkmcnt(0)
  v_pk_add_f32 v[32:33], v[32:33], v[60:61]
  v_pk_add_f32 v[34:35], v[34:35], v[62:63]
  v_pk_add_f32 v[36:37], v[36:37], v[64:65]
  v_pk_add_f32 v[38:39], v[38:39], v[66:67]
  v_pk_add_f32 v[32:33], v[32:33], v[68:69]
  v_pk_add_f32 v[34:35], v[34:35], v[70:71]
  v_pk_add_f32 v[36:37], v[36:37], v[72:73]
  v_pk_add_f32 v[38:39], v[38:39], v[74:75]
  v_pk_add_f32 v[32:33], v[32:33], v[76:77]
  v_pk_add_f32 v[34:35], v[34:35], v[78:79]
  v_pk_add_f32 v[36:37], v[36:37], v[80:81]
  v_pk_add_f32 v[38:39], v[38:39], v[82:83]
  v_cvt_pk_bf16_f32 v48, v32, v33
  v_cvt_pk_bf16_f32 v49, v34, v35
  v_cvt_pk_bf16_f32 v50, v36, v37
  v_cvt_pk_bf16_f32 v51, v38, v39
  v_lshlrev_b32 v32, 16, v48
  v_and_b32 v33, 0xffff0000, v48
  v_lshlrev_b32 v34, 16, v49
  v_and_b32 v35, 0xffff0000, v49
  v_lshlrev_b32 v36, 16, v50
  v_and_b32 v37, 0xffff0000, v50
  v_lshlrev_b32 v38, 16, v51
  v_and_b32 v39, 0xffff0000, v51
  v_add_f32 v32, v32, v40
  v_add_f32 v33, v33, v41
  v_add_f32 v34, v34, v42
  v_add_f32 v35, v35, v43
  v_add_f32 v36, v36, v44
  v_add_f32 v37, v37, v45
  v_add_f32 v38, v38, v46
  v_add_f32 v39, v39, v47
  v_cvt_pk_bf16_f32 v48, v32, v33
  v_cvt_pk_bf16_f32 v49, v34, v35
  v_cvt_pk_bf16_f32 v50, v36, v37
  v_cvt_pk_bf16_f32 v51, v38, v39
  v_lshlrev_b32 v32, 16, v48
  v_and_b32 v33, 0xffff0000, v48
  v_lshlrev_b32 v34, 16, v49
  v_and_b32 v35, 0xffff0000, v49
  v_lshlrev_b32 v36, 16, v50
  v_and_b32 v37, 0xffff0000, v50
  v_lshlrev_b32 v38, 16, v51
  v_and_b32 v39, 0xffff0000, v51
  v_mul_f32 v32, v32, v91
  v_mul_f32 v33, v33, v91
  v_mul_f32 v34, v34, v91
  v_mul_f32 v35, v35, v91
  v_mul_f32 v36, v36, v91
  v_mul_f32 v37, v37, v91
  v_mul_f32 v38, v38, v91
  v_mul_f32 v39, v39, v91
  v_cvt_pk_bf16_f32 v48, v32, v33
  v_cvt_pk_bf16_f32 v49, v34, v35
  v_cvt_pk_bf16_f32 v50, v36, v37
  v_cvt_pk_bf16_f32 v51, v38, v39
  v_lshlrev_b32 v32, 16, v48
  v_and_b32 v33, 0xffff0000, v48
  v_lshlrev_b32 v34, 16, v49
  v_and_b32 v35, 0xffff0000, v49
  v_lshlrev_b32 v36, 16, v50
  v_and_b32 v37, 0xffff0000, v50
  v_lshlrev_b32 v38, 16, v51
  v_and_b32 v39, 0xffff0000, v51
  v_add_f32 v32, v32, v16
  v_add_f32 v33, v33, v17
  v_add_f32 v34, v34, v18
  v_add_f32 v35, v35, v19
  v_add_f32 v36, v36, v20
  v_add_f32 v37, v37, v21
  v_add_f32 v38, v38, v22
  v_add_f32 v39, v39, v23
  v_cvt_pk_bf16_f32 v52, v32, v33
  v_cvt_pk_bf16_f32 v53, v34, v35
  v_cvt_pk_bf16_f32 v54, v36, v37
  v_cvt_pk_bf16_f32 v55, v38, v39
  s_nop 0
  v_permlane16_swap_b32 v52, v54
  v_permlane16_swap_b32 v53, v55
  s_waitcnt vmcnt(1)
  global_store_dwordx4 v90, v[52:55], s[40:41] sc1
  s_barrier
  s_cmp_eq_u32 s42, 7
  s_cbranch_scc0 L_WS1
  s_lshl_b32 s51, s45, 3
  s_add_u32 s51, s51, s46
  s_lshl_b32 s51, s51, 3
  s_add_u32 s51, s51, 20221952
  v_mov_b32 v56, s51
  v_mov_b32 v58, s43
  v_mov_b32 v59, s43
  s_mov_b64 exec, 1
  global_store_dwordx2 v56, v[58:59], s[40:41] sc1
  s_mov_b64 exec, -1
L_WS1:
  s_add_u32 s50, s46, 8
  s_mul_i32 s50, s50, 7
  s_min_u32 s51, s42, 6
  s_add_u32 s50, s50, s51
  s_lshl_b32 s50, s50, 14
  s_add_u32 s50, s50, 9437184
  v_lshlrev_b32 v4, 4, v1
  v_add_u32 v4, s50, v4
  s_cmp_lt_u32 s42, 7
  s_cbranch_scc0 L_NOWZ1A
  v_subrev_u32 v7, 917504, v4
  global_load_dwordx4 v[128:131], v7, s[40:41] offset:0 sc1
  global_load_dwordx4 v[132:135], v7, s[40:41] offset:1024 sc1
  global_load_dwordx4 v[136:139], v7, s[40:41] offset:2048 sc1
  global_load_dwordx4 v[140:143], v7, s[40:41] offset:3072 sc1
  v_subrev_u32 v7, 913408, v4
  global_load_dwordx4 v[144:147], v7, s[40:41] offset:0 sc1
  global_load_dwordx4 v[148:151], v7, s[40:41] offset:1024 sc1
  global_load_dwordx4 v[152:155], v7, s[40:41] offset:2048 sc1
  global_load_dwordx4 v[156:159], v7, s[40:41] offset:3072 sc1
L_NOWZ1A:
  v_lshrrev_b32 v28, 3, v1
  s_lshl_b32 s50, s42, 3
  v_add_u32 v28, s50, v28
  v_and_b32 v29, 7, v1
  v_lshlrev_b32 v30, 15, v28
  v_lshl_add_u32 v30, v29, 4, v30
  s_lshl_b32 s50, s45, 7
  v_add_u32 v30, s50, v30
  s_barrier
  v_mov_b32 v7, v30
  global_load_dwordx4 v[32:35], v7, s[40:41] sc1
  v_add_u32 v7, 4096, v7
  global_load_dwordx4 v[36:39], v7, s[40:41] sc1
  v_add_u32 v7, 4096, v7
  global_load_dwordx4 v[40:43], v7, s[40:41] sc1
  v_add_u32 v7, 4096, v7
  global_load_dwordx4 v[44:47], v7, s[40:41] sc1
  v_add_u32 v7, 4096, v7
  global_load_dwordx4 v[48:51], v7, s[40:41] sc1
  v_add_u32 v7, 4096, v7
  global_load_dwordx4 v[52:55], v7, s[40:41] sc1
  v_add_u32 v7, 4096, v7
  global_load_dwordx4 v[56:59], v7, s[40:41] sc1
  v_add_u32 v7, 4096, v7
  global_load_dwordx4 v[60:63], v7, s[40:41] sc1
  s_cmp_lt_u32 s42, 7
  s_cbranch_scc0 L_NOWC2
  s_mov_b32 s60, 0
  s_branch L_WC2_CK
L_WC2_RE:
  s_add_u32 s60, s60, 1
  s_cmp_gt_u32 s60, 200000
  s_cbranch_scc1 L_WC2_OK
  v_mov_b32 v7, v4
  global_load_dwordx4 v[192:195], v7, s[40:41] offset:0 sc1
  global_load_dwordx4 v[196:199], v7, s[40:41] offset:1024 sc1
  global_load_dwordx4 v[200:203], v7, s[40:41] offset:2048 sc1
  global_load_dwordx4 v[204:207], v7, s[40:41] offset:3072 sc1
  v_add_u32 v7, 4096, v7
  global_load_dwordx4 v[208:211], v7, s[40:41] offset:0 sc1
  global_load_dwordx4 v[212:215], v7, s[40:41] offset:1024 sc1
  global_load_dwordx4 v[216:219], v7, s[40:41] offset:2048 sc1
  global_load_dwordx4 v[220:223], v7, s[40:41] offset:3072 sc1
  v_add_u32 v7, 4096, v7
  global_load_dwordx4 v[224:227], v7, s[40:41] offset:0 sc1
  global_load_dwordx4 v[228:231], v7, s[40:41] offset:1024 sc1
  global_load_dwordx4 v[232:235], v7, s[40:41] offset:2048 sc1
  global_load_dwordx4 v[236:239], v7, s[40:41] offset:3072 sc1
  v_add_u32 v7, 4096, v7
  global_load_dwordx4 v[240:243], v7, s[40:41] offset:0 sc1
  global_load_dwordx4 v[244:247], v7, s[40:41] offset:1024 sc1
  global_load_dwordx4 v[248:251], v7, s[40:41] offset:2048 sc1
  global_load_dwordx4 v[252:255], v7, s[40:41] offset:3072 sc1
  s_waitcnt vmcnt(0)
L_WC2_CK:
  v_max3_u32 v6, v192, v193, v194
  v_max3_u32 v6, v6, v195, v196
  v_max3_u32 v6, v6, v197, v198
  v_max3_u32 v6, v6, v199, v200
  v_max3_u32 v6, v6, v201, v202
  v_max3_u32 v6, v6, v203, v204
  v_max3_u32 v6, v6, v205, v206
  v_max3_u32 v6, v6, v207, v208
  v_max3_u32 v6, v6, v209, v210
  v_max3_u32 v6, v6, v211, v212
  v_max3_u32 v6, v6, v213, v214
  v_max3_u32 v6, v6, v215, v216
  v_max3_u32 v6, v6, v217, v218
  v_max3_u32 v6, v6, v219, v220
  v_max3_u32 v6, v6, v221, v222
  v_max3_u32 v6, v6, v223, v224
  v_max3_u32 v6, v6, v225, v226
  v_max3_u32 v6, v6, v227, v228
  v_max3_u32 v6, v6, v229, v230
  v_max3_u32 v6, v6, v231, v232
  v_max3_u32 v6, v6, v233, v234
  v_max3_u32 v6, v6, v235, v236
  v_max3_u32 v6, v6, v237, v238
  v_max3_u32 v6, v6, v239, v240
  v_max3_u32 v6, v6, v241, v242
  v_max3_u32 v6, v6, v243, v244
  v_max3_u32 v6, v6, v245, v246
  v_max3_u32 v6, v6, v247, v248
  v_max3_u32 v6, v6, v249, v250
  v_max3_u32 v6, v6, v251, v252
  v_max3_u32 v6, v6, v253, v254
  v_max_u32 v6, v6, v255
  v_cmp_eq_u32 vcc, -1, v6
  s_cbranch_vccnz L_WC2_RE
L_WC2_OK:
L_NOWC2:
  v_lshlrev_b32 v24, 6, v29
  v_bfe_u32 v6, v1, 4, 1
  v_lshl_add_u32 v24, v6, 3, v24
  v_lshrrev_b32 v6, 5, v1
  v_lshl_add_u32 v24, v6, 2, v24
  s_lshl_b32 s50, s42, 9
  s_add_u32 s50, s50, 65536
  v_add_u32 v24, s50, v24
  v_lshlrev_b32 v25, 3, v1
  v_add_u32 v25, 65536, v25
  s_add_u32 s50, s50, 4096
  v_lshlrev_b32 v26, 2, v1
  v_add_u32 v26, s50, v26
  v_lshlrev_b32 v27, 5, v29
  v_add_u32 v27, s50, v27
  v_and_b32 v31, 1, v29
  v_lshlrev_b32 v31, 3, v31
  v_xor_b32 v31, v31, v29
  v_xor_b32 v31, v31, v28
  s_cmp_lt_u32 s42, 7
  s_cbranch_scc1 L_W7_1_A
  s_waitcnt vmcnt(0)
  s_branch L_W7_1_B
L_W7_1_A:
  s_waitcnt vmcnt(0)
L_W7_1_B:
  s_mov_b32 s61, 0
  s_mov_b32 s60, 0
  s_branch L_PX_CK
L_PX:
  s_add_u32 s60, s60, 1
  s_cmp_gt_u32 s60, 200000
  s_cbranch_scc1 L_PX_X
  v_mov_b32 v7, v30
  global_load_dwordx4 v[32:35], v7, s[40:41] sc1
  v_add_u32 v7, 4096, v7
  global_load_dwordx4 v[36:39], v7, s[40:41] sc1
  v_add_u32 v7, 4096, v7
  global_load_dwordx4 v[40:43], v7, s[40:41] sc1
  v_add_u32 v7, 4096, v7
  global_load_dwordx4 v[44:47], v7, s[40:41] sc1
  v_add_u32 v7, 4096, v7
  global_load_dwordx4 v[48:51], v7, s[40:41] sc1
  v_add_u32 v7, 4096, v7
  global_load_dwordx4 v[52:55], v7, s[40:41] sc1
  v_add_u32 v7, 4096, v7
  global_load_dwordx4 v[56:59], v7, s[40:41] sc1
  v_add_u32 v7, 4096, v7
  global_load_dwordx4 v[60:63], v7, s[40:41] sc1
  s_waitcnt vmcnt(0)
L_PX_CK:
  v_max3_u32 v6, v32, v33, v34
  v_max3_u32 v6, v6, v35, v36
  v_max3_u32 v6, v6, v37, v38
  v_max3_u32 v6, v6, v39, v40
  v_max3_u32 v6, v6, v41, v42
  v_max3_u32 v6, v6, v43, v44
  v_max3_u32 v6, v6, v45, v46
  v_max3_u32 v6, v6, v47, v48
  v_max3_u32 v6, v6, v49, v50
  v_max3_u32 v6, v6, v51, v52
  v_max3_u32 v6, v6, v53, v54
  v_max3_u32 v6, v6, v55, v56
  v_max3_u32 v6, v6, v57, v58
  v_max3_u32 v6, v6, v59, v60
  v_max3_u32 v6, v6, v61, v62
  v_max_u32 v6, v6, v63
  v_cmp_eq_u32 vcc, -1, v6
  s_cbranch_vccnz L_PX
L_PX_X:
  s_mov_b32 s69, s60
  s_cmp_eq_u32 s42, s46
  s_cbranch_scc0 L_NOXR
  v_mov_b32 v68, 0x05040100
  v_mov_b32 v69, 0x07060302
  v_lshrrev_b32 v5, 3, v1
  v_lshlrev_b32 v5, 4, v5
  v_lshl_add_u32 v5, v29, 10, v5
  v_add_u32 v5, 155648, v5
  v_perm_b32 v72, v36, v32, v68
  v_perm_b32 v73, v44, v40, v68
  v_perm_b32 v74, v52, v48, v68
  v_perm_b32 v75, v60, v56, v68
  ds_write_b128 v5, v[72:75] offset:0
  v_perm_b32 v76, v36, v32, v69
  v_perm_b32 v77, v44, v40, v69
  v_perm_b32 v78, v52, v48, v69
  v_perm_b32 v79, v60, v56, v69
  ds_write_b128 v5, v[76:79] offset:128
  v_perm_b32 v72, v37, v33, v68
  v_perm_b32 v73, v45, v41, v68
  v_perm_b32 v74, v53, v49, v68
  v_perm_b32 v75, v61, v57, v68
  ds_write_b128 v5, v[72:75] offset:256
  v_perm_b32 v76, v37, v33, v69
  v_perm_b32 v77, v45, v41, v69
  v_perm_b32 v78, v53, v49, v69
  v_perm_b32 v79, v61, v57, v69
  ds_write_b128 v5, v[76:79] offset:384
  v_perm_b32 v72, v38, v34, v68
  v_perm_b32 v73, v46, v42, v68
  v_perm_b32 v74, v54, v50, v68
  v_perm_b32 v75, v62, v58, v68
  ds_write_b128 v5, v[72:75] offset:512
  v_perm_b32 v76, v38, v34, v69
  v_perm_b32 v77, v46, v42, v69
  v_perm_b32 v78, v54, v50, v69
  v_perm_b32 v79, v62, v58, v69
  ds_write_b128 v5, v[76:79] offset:640
  v_perm_b32 v72, v39, v35, v68
  v_perm_b32 v73, v47, v43, v68
  v_perm_b32 v74, v55, v51, v68
  v_perm_b32 v75, v63, v59, v68
  ds_write_b128 v5, v[72:75] offset:768
  v_perm_b32 v76, v39, v35, v69
  v_perm_b32 v77, v47, v43, v69
  v_perm_b32 v78, v55, v51, v69
  v_perm_b32 v79, v63, v59, v69
  ds_write_b128 v5, v[76:79] offset:896
L_NOXR:
  v_lshlrev_b32 v5, 5, v0
  v_add_u32 v5, 20299776, v5
  v_add_u32 v6, 16384, v5
  global_load_dwordx4 v[8:11], v5, s[40:41] sc1
  global_load_dwordx4 v[12:15], v5, s[40:41] offset:16 sc1
  global_load_dwordx4 v[16:19], v6, s[40:41] sc1
  global_load_dwordx4 v[20:23], v6, s[40:41] offset:16 sc1
  v_lshlrev_b32 v64, 16, v32
  v_and_b32 v65, 0xffff0000, v32
  v_lshlrev_b32 v66, 16, v33
  v_and_b32 v67, 0xffff0000, v33
  v_lshlrev_b32 v68, 16, v34
  v_and_b32 v69, 0xffff0000, v34
  v_lshlrev_b32 v70, 16, v35
  v_and_b32 v71, 0xffff0000, v35
  v_lshlrev_b32 v72, 16, v36
  v_and_b32 v73, 0xffff0000, v36
  v_lshlrev_b32 v74, 16, v37
  v_and_b32 v75, 0xffff0000, v37
  v_lshlrev_b32 v76, 16, v38
  v_and_b32 v77, 0xffff0000, v38
  v_subrev_u32 v7, 909312, v4
  global_load_dwordx4 v[160:163], v7, s[40:41] offset:0 sc1
  v_lshlrev_b32 v78, 16, v39
  v_and_b32 v79, 0xffff0000, v39
  v_lshlrev_b32 v80, 16, v40
  v_and_b32 v81, 0xffff0000, v40
  v_lshlrev_b32 v82, 16, v41
  v_and_b32 v83, 0xffff0000, v41
  v_lshlrev_b32 v84, 16, v42
  v_and_b32 v85, 0xffff0000, v42
  v_lshlrev_b32 v86, 16, v43
  v_and_b32 v87, 0xffff0000, v43
  v_lshlrev_b32 v88, 16, v44
  v_and_b32 v89, 0xffff0000, v44
  v_lshlrev_b32 v90, 16, v45
  v_and_b32 v91, 0xffff0000, v45
  global_load_dwordx4 v[164:167], v7, s[40:41] offset:1024 sc1
  v_lshlrev_b32 v92, 16, v46
  v_and_b32 v93, 0xffff0000, v46
  v_lshlrev_b32 v94, 16, v47
  v_and_b32 v95, 0xffff0000, v47
  v_lshlrev_b32 v96, 16, v48
  v_and_b32 v97, 0xffff0000, v48
  v_lshlrev_b32 v98, 16, v49
  v_and_b32 v99, 0xffff0000, v49
  v_lshlrev_b32 v100, 16, v50
  v_and_b32 v101, 0xffff0000, v50
  v_lshlrev_b32 v102, 16, v51
  v_and_b32 v103, 0xffff0000, v51
  v_lshlrev_b32 v104, 16, v52
  v_and_b32 v105, 0xffff0000, v52
  global_load_dwordx4 v[168:171], v7, s[40:41] offset:2048 sc1
  v_lshlrev_b32 v106, 16, v53
  v_and_b32 v107, 0xffff0000, v53
  v_lshlrev_b32 v108, 16, v54
  v_and_b32 v109, 0xffff0000, v54
  v_lshlrev_b32 v110, 16, v55
  v_and_b32 v111, 0xffff0000, v55
  v_lshlrev_b32 v112, 16, v56
  v_and_b32 v113, 0xffff0000, v56
  v_lshlrev_b32 v114, 16, v57
  v_and_b32 v115, 0xffff0000, v57
  v_lshlrev_b32 v116, 16, v58
  v_and_b32 v117, 0xffff0000, v58
  v_lshlrev_b32 v118, 16, v59
  v_and_b32 v119, 0xffff0000, v59
  global_load_dwordx4 v[172:175], v7, s[40:41] offset:3072 sc1
  v_lshlrev_b32 v120, 16, v60
  v_and_b32 v121, 0xffff0000, v60
  v_lshlrev_b32 v122, 16, v61
  v_and_b32 v123, 0xffff0000, v61
  v_lshlrev_b32 v124, 16, v62
  v_and_b32 v125, 0xffff0000, v62
  v_lshlrev_b32 v126, 16, v63
  v_and_b32 v127, 0xffff0000, v63
  v_pk_add_f32 v[32:33], v[64:65], v[72:73]
  v_pk_mul_f32 v[40:41], v[64:65], v[64:65]
  v_pk_add_f32 v[34:35], v[66:67], v[74:75]
  v_pk_mul_f32 v[42:43], v[66:67], v[66:67]
  v_pk_add_f32 v[36:37], v[68:69], v[76:77]
  v_pk_mul_f32 v[44:45], v[68:69], v[68:69]
  v_subrev_u32 v7, 905216, v4
  global_load_dwordx4 v[176:179], v7, s[40:41] offset:0 sc1
  v_pk_add_f32 v[38:39], v[70:71], v[78:79]
  v_pk_mul_f32 v[46:47], v[70:71], v[70:71]
  v_pk_fma_f32 v[40:41], v[72:73], v[72:73], v[40:41]
  v_pk_fma_f32 v[42:43], v[74:75], v[74:75], v[42:43]
  v_pk_fma_f32 v[44:45], v[76:77], v[76:77], v[44:45]
  v_pk_fma_f32 v[46:47], v[78:79], v[78:79], v[46:47]
  v_pk_add_f32 v[32:33], v[32:33], v[80:81]
  v_pk_fma_f32 v[40:41], v[80:81], v[80:81], v[40:41]
  v_pk_add_f32 v[34:35], v[34:35], v[82:83]
  v_pk_fma_f32 v[42:43], v[82:83], v[82:83], v[42:43]
  v_pk_add_f32 v[36:37], v[36:37], v[84:85]
  v_pk_fma_f32 v[44:45], v[84:85], v[84:85], v[44:45]
  v_pk_add_f32 v[38:39], v[38:39], v[86:87]
  v_pk_fma_f32 v[46:47], v[86:87], v[86:87], v[46:47]
  global_load_dwordx4 v[180:183], v7, s[40:41] offset:1024 sc1
  v_pk_add_f32 v[32:33], v[32:33], v[88:89]
  v_pk_fma_f32 v[40:41], v[88:89], v[88:89], v[40:41]
  v_pk_add_f32 v[34:35], v[34:35], v[90:91]
  v_pk_fma_f32 v[42:43], v[90:91], v[90:91], v[42:43]
  v_pk_add_f32 v[36:37], v[36:37], v[92:93]
  v_pk_fma_f32 v[44:45], v[92:93], v[92:93], v[44:45]
  v_pk_add_f32 v[38:39], v[38:39], v[94:95]
  v_pk_fma_f32 v[46:47], v[94:95], v[94:95], v[46:47]
  v_pk_add_f32 v[32:33], v[32:33], v[96:97]
  v_pk_fma_f32 v[40:41], v[96:97], v[96:97], v[40:41]
  v_pk_add_f32 v[34:35], v[34:35], v[98:99]
  v_pk_fma_f32 v[42:43], v[98:99], v[98:99], v[42:43]
  v_pk_add_f32 v[36:37], v[36:37], v[100:101]
  v_pk_fma_f32 v[44:45], v[100:101], v[100:101], v[44:45]
  global_load_dwordx4 v[184:187], v7, s[40:41] offset:2048 sc1
  v_pk_add_f32 v[38:39], v[38:39], v[102:103]
  v_pk_fma_f32 v[46:47], v[102:103], v[102:103], v[46:47]
  v_pk_add_f32 v[32:33], v[32:33], v[104:105]
  v_pk_fma_f32 v[40:41], v[104:105], v[104:105], v[40:41]
  v_pk_add_f32 v[34:35], v[34:35], v[106:107]
  v_pk_fma_f32 v[42:43], v[106:107], v[106:107], v[42:43]
  v_pk_add_f32 v[36:37], v[36:37], v[108:109]
  v_pk_fma_f32 v[44:45], v[108:109], v[108:109], v[44:45]
  v_pk_add_f32 v[38:39], v[38:39], v[110:111]
  v_pk_fma_f32 v[46:47], v[110:111], v[110:111], v[46:47]
  v_pk_add_f32 v[32:33], v[32:33], v[112:113]
  v_pk_fma_f32 v[40:41], v[112:113], v[112:113], v[40:41]
  v_pk_add_f32 v[34:35], v[34:35], v[114:115]
  v_pk_fma_f32 v[42:43], v[114:115], v[114:115], v[42:43]
  global_load_dwordx4 v[188:191], v7, s[40:41] offset:3072 sc1
  v_pk_add_f32 v[36:37], v[36:37], v[116:117]
  v_pk_fma_f32 v[44:45], v[116:117], v[116:117], v[44:45]
  v_pk_add_f32 v[38:39], v[38:39], v[118:119]
  v_pk_fma_f32 v[46:47], v[118:119], v[118:119], v[46:47]
  v_pk_add_f32 v[32:33], v[32:33], v[120:121]
  v_pk_fma_f32 v[40:41], v[120:121], v[120:121], v[40:41]
  v_pk_add_f32 v[34:35], v[34:35], v[122:123]
  v_pk_fma_f32 v[42:43], v[122:123], v[122:123], v[42:43]
  v_pk_add_f32 v[36:37], v[36:37], v[124:125]
  v_pk_fma_f32 v[44:45], v[124:125], v[124:125], v[44:45]
  v_pk_add_f32 v[38:39], v[38:39], v[126:127]
  v_pk_fma_f32 v[46:47], v[126:127], v[126:127], v[46:47]
  v_permlane32_swap_b32 v32, v40
  v_permlane32_swap_b32 v33, v41
  v_permlane32_swap_b32 v34, v42
  v_permlane32_swap_b32 v35, v43
  v_permlane32_swap_b32 v36, v44
  v_permlane32_swap_b32 v37, v45
  v_permlane32_swap_b32 v38, v46
  v_permlane32_swap_b32 v39, v47
  v_add_f32 v32, v32, v40
  v_add_f32 v33, v33, v41
  v_add_f32 v34, v34, v42
  v_add_f32 v35, v35, v43
  v_add_f32 v36, v36, v44
  v_add_f32 v37, v37, v45
  v_add_f32 v38, v38, v46
  v_add_f32 v39, v39, v47
  v_permlane16_swap_b32 v32, v33
  v_permlane16_swap_b32 v34, v35
  v_permlane16_swap_b32 v36, v37
  v_permlane16_swap_b32 v38, v39
  v_add_f32 v32, v32, v33
  v_add_f32 v34, v34, v35
  v_add_f32 v36, v36, v37
  v_add_f32 v38, v38, v39
  v_add_f32_dpp v32, v32, v32 row_ror:8 row_mask:0xf bank_mask:0xf
  v_add_f32_dpp v34, v34, v34 row_ror:8 row_mask:0xf bank_mask:0xf
  v_add_f32_dpp v36, v36, v36 row_ror:8 row_mask:0xf bank_mask:0xf
  v_add_f32_dpp v38, v38, v38 row_ror:8 row_mask:0xf bank_mask:0xf
  s_waitcnt vmcnt(8)
  v_xor_b32 v6, v3, v9
  v_xor_b32 v7, v3, v11
  v_or_b32 v6, v6, v7
  v_xor_b32 v7, v3, v13
  v_or_b32 v6, v6, v7
  v_xor_b32 v7, v3, v15
  v_or_b32 v6, v6, v7
  v_xor_b32 v7, v3, v17
  v_or_b32 v6, v6, v7
  v_xor_b32 v7, v3, v19
  v_or_b32 v6, v6, v7
  v_xor_b32 v7, v3, v21
  v_or_b32 v6, v6, v7
  v_xor_b32 v7, v3, v23
  v_or_b32 v6, v6, v7
  v_cmp_ne_u32 vcc, 0, v6
  s_cbranch_vccz L_MC_OK
  v_lshlrev_b32 v48, 5, v0
  v_add_u32 v48, 20299776, v48
  v_add_u32 v49, 16384, v48
  s_mov_b32 s60, 0
L_PMC:
  global_load_dwordx4 v[8:11], v48, s[40:41] sc1
  global_load_dwordx4 v[12:15], v48, s[40:41] offset:16 sc1
  global_load_dwordx4 v[16:19], v49, s[40:41] sc1
  global_load_dwordx4 v[20:23], v49, s[40:41] offset:16 sc1
  s_waitcnt vmcnt(0)
  v_xor_b32 v6, v3, v9
  v_xor_b32 v7, v3, v11
  v_or_b32 v6, v6, v7
  v_xor_b32 v7, v3, v13
  v_or_b32 v6, v6, v7
  v_xor_b32 v7, v3, v15
  v_or_b32 v6, v6, v7
  v_xor_b32 v7, v3, v17
  v_or_b32 v6, v6, v7
  v_xor_b32 v7, v3, v19
  v_or_b32 v6, v6, v7
  v_xor_b32 v7, v3, v21
  v_or_b32 v6, v6, v7
  v_xor_b32 v7, v3, v23
  v_or_b32 v6, v6, v7
  v_cmp_ne_u32 vcc, 0, v6
  s_add_u32 s60, s60, 1
  s_cmp_gt_u32 s60, 200000
  s_cbranch_scc1 L_PMC_X
  s_cbranch_vccnz L_PMC
L_PMC_X:
L_MC_OK:
  v_add_f32 v8, v8, v10
  v_add_f32 v12, v12, v14
  v_add_f32 v8, v8, v12
  v_add_f32 v16, v16, v18
  v_add_f32 v20, v20, v22
  v_add_f32 v16, v16, v20
  v_cvt_pk_bf16_f32 v6, v8, v16
  v_lshlrev_b32 v8, 16, v6
  v_and_b32 v16, 0xffff0000, v6
  v_add_f32 v16, 1.0, v16
  v_cvt_pk_bf16_f32 v6, v16, v16
  v_and_b32 v16, 0xffff0000, v6
  v_lshlrev_b32 v6, 2, v0
  v_add_u32 v7, 73728, v6
  ds_write_b32 v7, v16
  ds_write_b32 v7, v8 offset:2048
  ds_write_b32 v24, v32 offset:0
  ds_write_b32 v24, v34 offset:16
  ds_write_b32 v24, v36 offset:32
  ds_write_b32 v24, v38 offset:48
  s_waitcnt lgkmcnt(0)
  s_barrier
  ds_read_b64 v[32:33], v25 offset:0
  ds_read_b64 v[34:35], v25 offset:512
  ds_read_b64 v[36:37], v25 offset:1024
  ds_read_b64 v[38:39], v25 offset:1536
  ds_read_b64 v[40:41], v25 offset:2048
  ds_read_b64 v[42:43], v25 offset:2560
  ds_read_b64 v[44:45], v25 offset:3072
  ds_read_b64 v[46:47], v25 offset:3584
  v_lshlrev_b32 v6, 5, v28
  v_add_u32 v6, 73728, v6
  ds_read_b128 v[16:19], v6
  ds_read_b128 v[20:23], v6 offset:16
  ds_read_b128 v[8:11], v6 offset:2048
  ds_read_b128 v[12:15], v6 offset:2064
  s_waitcnt lgkmcnt(0)
  v_pk_add_f32 v[32:33], v[32:33], v[34:35]
  v_pk_add_f32 v[36:37], v[36:37], v[38:39]
  v_pk_add_f32 v[40:41], v[40:41], v[42:43]
  v_pk_add_f32 v[44:45], v[44:45], v[46:47]
  v_pk_add_f32 v[32:33], v[32:33], v[36:37]
  v_pk_add_f32 v[40:41], v[40:41], v[44:45]
  v_pk_add_f32 v[32:33], v[32:33], v[40:41]
  v_mul_f32 v32, 0x3b000000, v32
  v_mul_f32 v33, 0x3b000000, v33
  v_fma_f32 v33, -v32, v32, v33
  v_max_f32 v33, 0, v33
  v_cvt_pk_bf16_f32 v34, v32, v33
  v_lshlrev_b32 v32, 16, v34
  v_and_b32 v33, 0xffff0000, v34
  v_add_f32 v33, 0x3727c5ac, v33
  v_cvt_pk_bf16_f32 v34, v33, v33
  v_and_b32 v33, 0xffff0000, v34
  v_sqrt_f32 v33, v33
  s_nop 0
  v_cvt_pk_bf16_f32 v34, v33, v33
  v_and_b32 v33, 0xffff0000, v34
  v_rcp_f32 v34, v33
  s_nop 0
  v_mul_f32 v33, -v32, v34
  v_mov_b32 v32, v34
  ds_write_b32 v26, v32
  ds_write_b32 v26, v33 offset:256
  v_lshlrev_b32 v6, 13, v29
  v_and_b32 v5, 7, v1
  s_lshl_b32 s50, s45, 3
  v_add_u32 v5, s50, v5
  v_lshlrev_b32 v5, 3, v5
  v_add_u32 v5, 20221952, v5
  global_load_dword v2, v5, s[40:41] sc1
  s_waitcnt lgkmcnt(0)
  ds_read_b128 v[32:35], v27
  ds_read_b128 v[36:39], v27 offset:16
  ds_read_b128 v[40:43], v27 offset:256
  ds_read_b128 v[44:47], v27 offset:272
  s_waitcnt lgkmcnt(0)
  v_pk_fma_f32 v[64:65], v[64:65], v[32:33], v[40:41]
  v_pk_fma_f32 v[72:73], v[72:73], v[32:33], v[40:41]
  v_pk_fma_f32 v[80:81], v[80:81], v[32:33], v[40:41]
  v_pk_fma_f32 v[88:89], v[88:89], v[32:33], v[40:41]
  v_pk_fma_f32 v[96:97], v[96:97], v[32:33], v[40:41]
  v_pk_fma_f32 v[104:105], v[104:105], v[32:33], v[40:41]
  v_pk_fma_f32 v[112:113], v[112:113], v[32:33], v[40:41]
  v_pk_fma_f32 v[120:121], v[120:121], v[32:33], v[40:41]
  v_pk_fma_f32 v[64:65], v[64:65], v[16:17], v[8:9] op_sel:[0,0,0] op_sel_hi:[1,0,0]
  v_pk_fma_f32 v[72:73], v[72:73], v[16:17], v[8:9] op_sel:[0,1,1] op_sel_hi:[1,1,1]
  v_pk_fma_f32 v[80:81], v[80:81], v[18:19], v[10:11] op_sel:[0,0,0] op_sel_hi:[1,0,0]
  v_pk_fma_f32 v[88:89], v[88:89], v[18:19], v[10:11] op_sel:[0,1,1] op_sel_hi:[1,1,1]
  v_pk_fma_f32 v[96:97], v[96:97], v[20:21], v[12:13] op_sel:[0,0,0] op_sel_hi:[1,0,0]
  v_pk_fma_f32 v[104:105], v[104:105], v[20:21], v[12:13] op_sel:[0,1,1] op_sel_hi:[1,1,1]
  v_pk_fma_f32 v[112:113], v[112:113], v[22:23], v[14:15] op_sel:[0,0,0] op_sel_hi:[1,0,0]
  v_pk_fma_f32 v[120:121], v[120:121], v[22:23], v[14:15] op_sel:[0,1,1] op_sel_hi:[1,1,1]
  v_cvt_pk_bf16_f32 v48, v64, v72
  v_cvt_pk_bf16_f32 v49, v80, v88
  v_cvt_pk_bf16_f32 v50, v96, v104
  v_cvt_pk_bf16_f32 v51, v112, v120
  v_xor_b32 v5, 0, v31
  v_lshl_add_u32 v5, v5, 4, v6
  ds_write_b128 v5, v[48:51] offset:0
  v_cvt_pk_bf16_f32 v52, v65, v73
  v_cvt_pk_bf16_f32 v53, v81, v89
  v_cvt_pk_bf16_f32 v54, v97, v105
  v_cvt_pk_bf16_f32 v55, v113, v121
  v_xor_b32 v5, 1, v31
  v_lshl_add_u32 v5, v5, 4, v6
  ds_write_b128 v5, v[52:55] offset:1024
  v_pk_fma_f32 v[66:67], v[66:67], v[34:35], v[42:43]
  v_pk_fma_f32 v[74:75], v[74:75], v[34:35], v[42:43]
  v_pk_fma_f32 v[82:83], v[82:83], v[34:35], v[42:43]
  v_pk_fma_f32 v[90:91], v[90:91], v[34:35], v[42:43]
  v_pk_fma_f32 v[98:99], v[98:99], v[34:35], v[42:43]
  v_pk_fma_f32 v[106:107], v[106:107], v[34:35], v[42:43]
  v_pk_fma_f32 v[114:115], v[114:115], v[34:35], v[42:43]
  v_pk_fma_f32 v[122:123], v[122:123], v[34:35], v[42:43]
  v_pk_fma_f32 v[66:67], v[66:67], v[16:17], v[8:9] op_sel:[0,0,0] op_sel_hi:[1,0,0]
  v_pk_fma_f32 v[74:75], v[74:75], v[16:17], v[8:9] op_sel:[0,1,1] op_sel_hi:[1,1,1]
  v_pk_fma_f32 v[82:83], v[82:83], v[18:19], v[10:11] op_sel:[0,0,0] op_sel_hi:[1,0,0]
  v_pk_fma_f32 v[90:91], v[90:91], v[18:19], v[10:11] op_sel:[0,1,1] op_sel_hi:[1,1,1]
  v_pk_fma_f32 v[98:99], v[98:99], v[20:21], v[12:13] op_sel:[0,0,0] op_sel_hi:[1,0,0]
  v_pk_fma_f32 v[106:107], v[106:107], v[20:21], v[12:13] op_sel:[0,1,1] op_sel_hi:[1,1,1]
  v_pk_fma_f32 v[114:115], v[114:115], v[22:23], v[14:15] op_sel:[0,0,0] op_sel_hi:[1,0,0]
  v_pk_fma_f32 v[122:123], v[122:123], v[22:23], v[14:15] op_sel:[0,1,1] op_sel_hi:[1,1,1]
  v_cvt_pk_bf16_f32 v56, v66, v74
  v_cvt_pk_bf16_f32 v57, v82, v90
  v_cvt_pk_bf16_f32 v58, v98, v106
  v_cvt_pk_bf16_f32 v59, v114, v122
  v_xor_b32 v5, 2, v31
  v_lshl_add_u32 v5, v5, 4, v6
  ds_write_b128 v5, v[56:59] offset:2048
  v_cvt_pk_bf16_f32 v60, v67, v75
  v_cvt_pk_bf16_f32 v61, v83, v91
  v_cvt_pk_bf16_f32 v62, v99, v107
  v_cvt_pk_bf16_f32 v63, v115, v123
  v_xor_b32 v5, 3, v31
  v_lshl_add_u32 v5, v5, 4, v6
  ds_write_b128 v5, v[60:63] offset:3072
  v_pk_fma_f32 v[68:69], v[68:69], v[36:37], v[44:45]
  v_pk_fma_f32 v[76:77], v[76:77], v[36:37], v[44:45]
  v_pk_fma_f32 v[84:85], v[84:85], v[36:37], v[44:45]
  v_pk_fma_f32 v[92:93], v[92:93], v[36:37], v[44:45]
  v_pk_fma_f32 v[100:101], v[100:101], v[36:37], v[44:45]
  v_pk_fma_f32 v[108:109], v[108:109], v[36:37], v[44:45]
  v_pk_fma_f32 v[116:117], v[116:117], v[36:37], v[44:45]
  v_pk_fma_f32 v[124:125], v[124:125], v[36:37], v[44:45]
  v_pk_fma_f32 v[68:69], v[68:69], v[16:17], v[8:9] op_sel:[0,0,0] op_sel_hi:[1,0,0]
  v_pk_fma_f32 v[76:77], v[76:77], v[16:17], v[8:9] op_sel:[0,1,1] op_sel_hi:[1,1,1]
  v_pk_fma_f32 v[84:85], v[84:85], v[18:19], v[10:11] op_sel:[0,0,0] op_sel_hi:[1,0,0]
  v_pk_fma_f32 v[92:93], v[92:93], v[18:19], v[10:11] op_sel:[0,1,1] op_sel_hi:[1,1,1]
  v_pk_fma_f32 v[100:101], v[100:101], v[20:21], v[12:13] op_sel:[0,0,0] op_sel_hi:[1,0,0]
  v_pk_fma_f32 v[108:109], v[108:109], v[20:21], v[12:13] op_sel:[0,1,1] op_sel_hi:[1,1,1]
  v_pk_fma_f32 v[116:117], v[116:117], v[22:23], v[14:15] op_sel:[0,0,0] op_sel_hi:[1,0,0]
  v_pk_fma_f32 v[124:125], v[124:125], v[22:23], v[14:15] op_sel:[0,1,1] op_sel_hi:[1,1,1]
  v_cvt_pk_bf16_f32 v48, v68, v76
  v_cvt_pk_bf16_f32 v49, v84, v92
  v_cvt_pk_bf16_f32 v50, v100, v108
  v_cvt_pk_bf16_f32 v51, v116, v124
  v_xor_b32 v5, 4, v31
  v_lshl_add_u32 v5, v5, 4, v6
  ds_write_b128 v5, v[48:51] offset:4096
  v_cvt_pk_bf16_f32 v52, v69, v77
  v_cvt_pk_bf16_f32 v53, v85, v93
  v_cvt_pk_bf16_f32 v54, v101, v109
  v_cvt_pk_bf16_f32 v55, v117, v125
  v_xor_b32 v5, 5, v31
  v_lshl_add_u32 v5, v5, 4, v6
  ds_write_b128 v5, v[52:55] offset:5120
  v_pk_fma_f32 v[70:71], v[70:71], v[38:39], v[46:47]
  v_pk_fma_f32 v[78:79], v[78:79], v[38:39], v[46:47]
  v_pk_fma_f32 v[86:87], v[86:87], v[38:39], v[46:47]
  v_pk_fma_f32 v[94:95], v[94:95], v[38:39], v[46:47]
  v_pk_fma_f32 v[102:103], v[102:103], v[38:39], v[46:47]
  v_pk_fma_f32 v[110:111], v[110:111], v[38:39], v[46:47]
  v_pk_fma_f32 v[118:119], v[118:119], v[38:39], v[46:47]
  v_pk_fma_f32 v[126:127], v[126:127], v[38:39], v[46:47]
  v_pk_fma_f32 v[70:71], v[70:71], v[16:17], v[8:9] op_sel:[0,0,0] op_sel_hi:[1,0,0]
  v_pk_fma_f32 v[78:79], v[78:79], v[16:17], v[8:9] op_sel:[0,1,1] op_sel_hi:[1,1,1]
  v_pk_fma_f32 v[86:87], v[86:87], v[18:19], v[10:11] op_sel:[0,0,0] op_sel_hi:[1,0,0]
  v_pk_fma_f32 v[94:95], v[94:95], v[18:19], v[10:11] op_sel:[0,1,1] op_sel_hi:[1,1,1]
  v_pk_fma_f32 v[102:103], v[102:103], v[20:21], v[12:13] op_sel:[0,0,0] op_sel_hi:[1,0,0]
  v_pk_fma_f32 v[110:111], v[110:111], v[20:21], v[12:13] op_sel:[0,1,1] op_sel_hi:[1,1,1]
  v_pk_fma_f32 v[118:119], v[118:119], v[22:23], v[14:15] op_sel:[0,0,0] op_sel_hi:[1,0,0]
  v_pk_fma_f32 v[126:127], v[126:127], v[22:23], v[14:15] op_sel:[0,1,1] op_sel_hi:[1,1,1]
  v_cvt_pk_bf16_f32 v56, v70, v78
  v_cvt_pk_bf16_f32 v57, v86, v94
  v_cvt_pk_bf16_f32 v58, v102, v110
  v_cvt_pk_bf16_f32 v59, v118, v126
  v_xor_b32 v5, 6, v31
  v_lshl_add_u32 v5, v5, 4, v6
  ds_write_b128 v5, v[56:59] offset:6144
  v_cvt_pk_bf16_f32 v60, v71, v79
  v_cvt_pk_bf16_f32 v61, v87, v95
  v_cvt_pk_bf16_f32 v62, v103, v111
  v_cvt_pk_bf16_f32 v63, v119, v127
  v_xor_b32 v5, 7, v31
  v_lshl_add_u32 v5, v5, 4, v6
  ds_write_b128 v5, v[60:63] offset:7168
  v_and_b32 v28, 15, v1
  v_lshrrev_b32 v29, 4, v1
  v_lshrrev_b32 v5, 3, v28
  v_xor_b32 v5, v5, v28
  v_xor_b32 v5, v5, v29
  v_lshlrev_b32 v6, 10, v28
  v_xor_b32 v7, 0, v5
  v_lshl_add_u32 v16, v7, 4, v6
  v_xor_b32 v7, 2, v5
  v_lshl_add_u32 v17, v7, 4, v6
  v_xor_b32 v7, 4, v5
  v_lshl_add_u32 v18, v7, 4, v6
  v_xor_b32 v7, 6, v5
  v_lshl_add_u32 v19, v7, 4, v6
  v_xor_b32 v7, 8, v5
  v_lshl_add_u32 v20, v7, 4, v6
  v_xor_b32 v7, 10, v5
  v_lshl_add_u32 v21, v7, 4, v6
  v_xor_b32 v7, 12, v5
  v_lshl_add_u32 v22, v7, 4, v6
  v_xor_b32 v7, 14, v5
  v_lshl_add_u32 v23, v7, 4, v6
  s_waitcnt vmcnt(0)
  v_cmp_ne_u32 vcc, v3, v2
  s_cbranch_vccz L_PWS_2_X2
  v_and_b32 v7, 7, v1
  s_lshl_b32 s50, s45, 3
  v_add_u32 v7, s50, v7
  v_lshlrev_b32 v7, 3, v7
  v_add_u32 v7, 20221952, v7
  s_mov_b32 s60, 0
L_PWS_2:
  global_load_dword v2, v7, s[40:41] sc1
  s_waitcnt vmcnt(0)
  v_xor_b32 v10, v3, v2
  v_cmp_ne_u32 vcc, 0, v10
  s_add_u32 s60, s60, 1
  s_cmp_gt_u32 s60, 200000
  s_cbranch_scc1 L_PWS_2_X
  s_cbranch_vccnz L_PWS_2
L_PWS_2_X:
L_PWS_2_X2:
  s_lshl_b32 s50, s45, 3
  s_add_u32 s50, s50, s42
  s_lshl_b32 s50, s50, 15
  s_add_u32 s50, s50, 11534336
  v_lshlrev_b32 v9, 4, v1
  v_add_u32 v9, s50, v9
  v_mov_b32 v2, 0xbdd2d3e8
  v_subrev_u32 v30, 917504, v4
  s_waitcnt lgkmcnt(0)
  s_barrier
  s_cmp_lt_u32 s42, 7
  s_cbranch_scc0 L_C_W7A
  ds_read_b128 v[64:67], v16 offset:0
  ds_read_b128 v[68:71], v17 offset:16384
  ds_read_b128 v[72:75], v18 offset:32768
  ds_read_b128 v[76:79], v19 offset:49152
  ds_read_b128 v[80:83], v18 offset:0
  ds_read_b128 v[84:87], v19 offset:16384
  ds_read_b128 v[88:91], v16 offset:32768
  ds_read_b128 v[92:95], v17 offset:49152
  ds_read_b128 v[96:99], v20 offset:0
  ds_read_b128 v[100:103], v21 offset:16384
  ds_read_b128 v[104:107], v22 offset:32768
  ds_read_b128 v[108:111], v23 offset:49152
  s_waitcnt lgkmcnt(8)
  v_mfma_f32_16x16x32_bf16 v[112:115], v[192:195], v[64:67], 0
  v_mfma_f32_16x16x32_bf16 v[116:119], v[192:195], v[68:71], 0
  v_mfma_f32_16x16x32_bf16 v[120:123], v[192:195], v[72:75], 0
  v_mfma_f32_16x16x32_bf16 v[124:127], v[192:195], v[76:79], 0
  v_add_u32 v10, 16384, v9
  global_load_dwordx4 v[192:195], v10, s[40:41] offset:0 sc1
  ds_read_b128 v[64:67], v22 offset:0
  ds_read_b128 v[68:71], v23 offset:16384
  ds_read_b128 v[72:75], v20 offset:32768
  ds_read_b128 v[76:79], v21 offset:49152
  s_waitcnt lgkmcnt(8)
  v_mfma_f32_16x16x32_bf16 v[112:115], v[196:199], v[80:83], v[112:115]
  v_mfma_f32_16x16x32_bf16 v[116:119], v[196:199], v[84:87], v[116:119]
  v_mfma_f32_16x16x32_bf16 v[120:123], v[196:199], v[88:91], v[120:123]
  v_mfma_f32_16x16x32_bf16 v[124:127], v[196:199], v[92:95], v[124:127]
  global_load_dwordx4 v[196:199], v10, s[40:41] offset:1024 sc1
  ds_read_b128 v[80:83], v16 offset:256
  ds_read_b128 v[84:87], v17 offset:16640
  ds_read_b128 v[88:91], v18 offset:33024
  ds_read_b128 v[92:95], v19 offset:49408
  s_waitcnt lgkmcnt(8)
  v_mfma_f32_16x16x32_bf16 v[112:115], v[200:203], v[96:99], v[112:115]
  v_mfma_f32_16x16x32_bf16 v[116:119], v[200:203], v[100:103], v[116:119]
  v_mfma_f32_16x16x32_bf16 v[120:123], v[200:203], v[104:107], v[120:123]
  v_mfma_f32_16x16x32_bf16 v[124:127], v[200:203], v[108:111], v[124:127]
  global_load_dwordx4 v[200:203], v10, s[40:41] offset:2048 sc1
  ds_read_b128 v[96:99], v18 offset:256
  ds_read_b128 v[100:103], v19 offset:16640
  ds_read_b128 v[104:107], v16 offset:33024
  ds_read_b128 v[108:111], v17 offset:49408
  s_waitcnt lgkmcnt(8)
  v_mfma_f32_16x16x32_bf16 v[112:115], v[204:207], v[64:67], v[112:115]
  v_mfma_f32_16x16x32_bf16 v[116:119], v[204:207], v[68:71], v[116:119]
  v_mfma_f32_16x16x32_bf16 v[120:123], v[204:207], v[72:75], v[120:123]
  v_mfma_f32_16x16x32_bf16 v[124:127], v[204:207], v[76:79], v[124:127]
  global_load_dwordx4 v[204:207], v10, s[40:41] offset:3072 sc1
  ds_read_b128 v[64:67], v20 offset:256
  ds_read_b128 v[68:71], v21 offset:16640
  ds_read_b128 v[72:75], v22 offset:33024
  ds_read_b128 v[76:79], v23 offset:49408
  s_waitcnt lgkmcnt(8)
  v_mfma_f32_16x16x32_bf16 v[112:115], v[208:211], v[80:83], v[112:115]
  v_mfma_f32_16x16x32_bf16 v[116:119], v[208:211], v[84:87], v[116:119]
  v_mfma_f32_16x16x32_bf16 v[120:123], v[208:211], v[88:91], v[120:123]
  v_mfma_f32_16x16x32_bf16 v[124:127], v[208:211], v[92:95], v[124:127]
  v_add_u32 v10, 20480, v9
  global_load_dwordx4 v[208:211], v10, s[40:41] offset:0 sc1
  ds_read_b128 v[80:83], v22 offset:256
  ds_read_b128 v[84:87], v23 offset:16640
  ds_read_b128 v[88:91], v20 offset:33024
  ds_read_b128 v[92:95], v21 offset:49408
  s_waitcnt lgkmcnt(8)
  v_mfma_f32_16x16x32_bf16 v[112:115], v[212:215], v[96:99], v[112:115]
  v_mfma_f32_16x16x32_bf16 v[116:119], v[212:215], v[100:103], v[116:119]
  v_mfma_f32_16x16x32_bf16 v[120:123], v[212:215], v[104:107], v[120:123]
  v_mfma_f32_16x16x32_bf16 v[124:127], v[212:215], v[108:111], v[124:127]
  global_load_dwordx4 v[212:215], v10, s[40:41] offset:1024 sc1
  ds_read_b128 v[96:99], v16 offset:512
  ds_read_b128 v[100:103], v17 offset:16896
  ds_read_b128 v[104:107], v18 offset:33280
  ds_read_b128 v[108:111], v19 offset:49664
  s_waitcnt lgkmcnt(8)
  v_mfma_f32_16x16x32_bf16 v[112:115], v[216:219], v[64:67], v[112:115]
  v_mfma_f32_16x16x32_bf16 v[116:119], v[216:219], v[68:71], v[116:119]
  v_mfma_f32_16x16x32_bf16 v[120:123], v[216:219], v[72:75], v[120:123]
  v_mfma_f32_16x16x32_bf16 v[124:127], v[216:219], v[76:79], v[124:127]
  global_load_dwordx4 v[216:219], v10, s[40:41] offset:2048 sc1
  ds_read_b128 v[64:67], v18 offset:512
  ds_read_b128 v[68:71], v19 offset:16896
  ds_read_b128 v[72:75], v16 offset:33280
  ds_read_b128 v[76:79], v17 offset:49664
  s_waitcnt lgkmcnt(8)
  v_mfma_f32_16x16x32_bf16 v[112:115], v[220:223], v[80:83], v[112:115]
  v_mfma_f32_16x16x32_bf16 v[116:119], v[220:223], v[84:87], v[116:119]
  v_mfma_f32_16x16x32_bf16 v[120:123], v[220:223], v[88:91], v[120:123]
  v_mfma_f32_16x16x32_bf16 v[124:127], v[220:223], v[92:95], v[124:127]
  global_load_dwordx4 v[220:223], v10, s[40:41] offset:3072 sc1
  ds_read_b128 v[80:83], v20 offset:512
  ds_read_b128 v[84:87], v21 offset:16896
  ds_read_b128 v[88:91], v22 offset:33280
  ds_read_b128 v[92:95], v23 offset:49664
  s_waitcnt lgkmcnt(8)
  v_mfma_f32_16x16x32_bf16 v[112:115], v[224:227], v[96:99], v[112:115]
  v_mfma_f32_16x16x32_bf16 v[116:119], v[224:227], v[100:103], v[116:119]
  v_mfma_f32_16x16x32_bf16 v[120:123], v[224:227], v[104:107], v[120:123]
  v_mfma_f32_16x16x32_bf16 v[124:127], v[224:227], v[108:111], v[124:127]
  v_add_u32 v10, 24576, v9
  global_load_dwordx4 v[224:227], v10, s[40:41] offset:0 sc1
  ds_read_b128 v[96:99], v22 offset:512
  ds_read_b128 v[100:103], v23 offset:16896
  ds_read_b128 v[104:107], v20 offset:33280
  ds_read_b128 v[108:111], v21 offset:49664
  s_waitcnt lgkmcnt(8)
  v_mfma_f32_16x16x32_bf16 v[112:115], v[228:231], v[64:67], v[112:115]
  v_mfma_f32_16x16x32_bf16 v[116:119], v[228:231], v[68:71], v[116:119]
  v_mfma_f32_16x16x32_bf16 v[120:123], v[228:231], v[72:75], v[120:123]
  v_mfma_f32_16x16x32_bf16 v[124:127], v[228:231], v[76:79], v[124:127]
  global_load_dwordx4 v[228:231], v10, s[40:41] offset:1024 sc1
  ds_read_b128 v[64:67], v16 offset:768
  ds_read_b128 v[68:71], v17 offset:17152
  ds_read_b128 v[72:75], v18 offset:33536
  ds_read_b128 v[76:79], v19 offset:49920
  s_waitcnt lgkmcnt(8)
  v_mfma_f32_16x16x32_bf16 v[112:115], v[232:235], v[80:83], v[112:115]
  v_mfma_f32_16x16x32_bf16 v[116:119], v[232:235], v[84:87], v[116:119]
  v_mfma_f32_16x16x32_bf16 v[120:123], v[232:235], v[88:91], v[120:123]
  v_mfma_f32_16x16x32_bf16 v[124:127], v[232:235], v[92:95], v[124:127]
  global_load_dwordx4 v[232:235], v10, s[40:41] offset:2048 sc1
  ds_read_b128 v[80:83], v18 offset:768
  ds_read_b128 v[84:87], v19 offset:17152
  ds_read_b128 v[88:91], v16 offset:33536
  ds_read_b128 v[92:95], v17 offset:49920
  s_waitcnt lgkmcnt(8)
  v_mfma_f32_16x16x32_bf16 v[112:115], v[236:239], v[96:99], v[112:115]
  v_mfma_f32_16x16x32_bf16 v[116:119], v[236:239], v[100:103], v[116:119]
  v_mfma_f32_16x16x32_bf16 v[120:123], v[236:239], v[104:107], v[120:123]
  v_mfma_f32_16x16x32_bf16 v[124:127], v[236:239], v[108:111], v[124:127]
  global_load_dwordx4 v[236:239], v10, s[40:41] offset:3072 sc1
  ds_read_b128 v[96:99], v20 offset:768
  ds_read_b128 v[100:103], v21 offset:17152
  ds_read_b128 v[104:107], v22 offset:33536
  ds_read_b128 v[108:111], v23 offset:49920
  s_waitcnt lgkmcnt(8)
  v_mfma_f32_16x16x32_bf16 v[112:115], v[240:243], v[64:67], v[112:115]
  v_mfma_f32_16x16x32_bf16 v[116:119], v[240:243], v[68:71], v[116:119]
  v_mfma_f32_16x16x32_bf16 v[120:123], v[240:243], v[72:75], v[120:123]
  v_mfma_f32_16x16x32_bf16 v[124:127], v[240:243], v[76:79], v[124:127]
  v_add_u32 v10, 28672, v9
  global_load_dwordx4 v[240:243], v10, s[40:41] offset:0 sc1
  ds_read_b128 v[64:67], v22 offset:768
  ds_read_b128 v[68:71], v23 offset:17152
  ds_read_b128 v[72:75], v20 offset:33536
  ds_read_b128 v[76:79], v21 offset:49920
  s_waitcnt lgkmcnt(8)
  v_mfma_f32_16x16x32_bf16 v[112:115], v[244:247], v[80:83], v[112:115]
  v_mfma_f32_16x16x32_bf16 v[116:119], v[244:247], v[84:87], v[116:119]
  v_mfma_f32_16x16x32_bf16 v[120:123], v[244:247], v[88:91], v[120:123]
  v_mfma_f32_16x16x32_bf16 v[124:127], v[244:247], v[92:95], v[124:127]
  global_load_dwordx4 v[244:247], v10, s[40:41] offset:1024 sc1
  s_waitcnt lgkmcnt(4)
  v_mfma_f32_16x16x32_bf16 v[112:115], v[248:251], v[96:99], v[112:115]
  v_mfma_f32_16x16x32_bf16 v[116:119], v[248:251], v[100:103], v[116:119]
  v_mfma_f32_16x16x32_bf16 v[120:123], v[248:251], v[104:107], v[120:123]
  v_mfma_f32_16x16x32_bf16 v[124:127], v[248:251], v[108:111], v[124:127]
  global_load_dwordx4 v[248:251], v10, s[40:41] offset:2048 sc1
  s_waitcnt lgkmcnt(0)
  v_mfma_f32_16x16x32_bf16 v[112:115], v[252:255], v[64:67], v[112:115]
  v_mfma_f32_16x16x32_bf16 v[116:119], v[252:255], v[68:71], v[116:119]
  v_mfma_f32_16x16x32_bf16 v[120:123], v[252:255], v[72:75], v[120:123]
  v_mfma_f32_16x16x32_bf16 v[124:127], v[252:255], v[76:79], v[124:127]
  global_load_dwordx4 v[252:255], v10, s[40:41] offset:3072 sc1
  s_nop 3
  v_cvt_pk_bf16_f32 v24, v112, v113
  v_lshlrev_b32 v112, 16, v24
  v_and_b32 v113, 0xffff0000, v24
  v_cvt_pk_bf16_f32 v26, v114, v115
  v_lshlrev_b32 v114, 16, v26
  v_and_b32 v115, 0xffff0000, v26
  v_mul_f32 v24, v112, v112
  v_mul_f32 v25, v113, v113
  v_mul_f32 v26, v114, v114
  v_mul_f32 v27, v115, v115
  v_fmaak_f32 v24, v2, v24, 0xc0135761
  v_fmaak_f32 v25, v2, v25, 0xc0135761
  v_fmaak_f32 v26, v2, v26, 0xc0135761
  v_fmaak_f32 v27, v2, v27, 0xc0135761
  v_mul_f32 v24, v24, v112
  v_mul_f32 v25, v25, v113
  v_mul_f32 v26, v26, v114
  v_mul_f32 v27, v27, v115
  v_exp_f32 v24, v24
  v_exp_f32 v25, v25
  v_exp_f32 v26, v26
  v_exp_f32 v27, v27
  v_add_f32 v24, 1.0, v24
  v_add_f32 v25, 1.0, v25
  v_add_f32 v26, 1.0, v26
  v_add_f32 v27, 1.0, v27
  v_rcp_f32 v24, v24
  v_rcp_f32 v25, v25
  v_rcp_f32 v26, v26
  v_rcp_f32 v27, v27
  v_mul_f32 v112, v112, v24
  v_mul_f32 v113, v113, v25
  v_mul_f32 v114, v114, v26
  v_mul_f32 v115, v115, v27
  v_cvt_pk_bf16_f32 v24, v112, v113
  v_lshlrev_b32 v40, 16, v24
  v_and_b32 v41, 0xffff0000, v24
  v_cvt_pk_bf16_f32 v26, v114, v115
  v_lshlrev_b32 v42, 16, v26
  v_and_b32 v43, 0xffff0000, v26
  v_add_f32 v32, v40, v41
  v_mul_f32 v36, v40, v40
  v_add_f32 v32, v32, v42
  v_fma_f32 v36, v41, v41, v36
  v_add_f32 v32, v32, v43
  v_fma_f32 v36, v42, v42, v36
  v_fma_f32 v36, v43, v43, v36
  v_cvt_pk_bf16_f32 v24, v116, v117
  v_lshlrev_b32 v116, 16, v24
  v_and_b32 v117, 0xffff0000, v24
  v_cvt_pk_bf16_f32 v26, v118, v119
  v_lshlrev_b32 v118, 16, v26
  v_and_b32 v119, 0xffff0000, v26
  v_mul_f32 v24, v116, v116
  v_mul_f32 v25, v117, v117
  v_mul_f32 v26, v118, v118
  v_mul_f32 v27, v119, v119
  v_fmaak_f32 v24, v2, v24, 0xc0135761
  v_fmaak_f32 v25, v2, v25, 0xc0135761
  v_fmaak_f32 v26, v2, v26, 0xc0135761
  v_fmaak_f32 v27, v2, v27, 0xc0135761
  v_mul_f32 v24, v24, v116
  v_mul_f32 v25, v25, v117
  v_mul_f32 v26, v26, v118
  v_mul_f32 v27, v27, v119
  v_exp_f32 v24, v24
  v_exp_f32 v25, v25
  v_exp_f32 v26, v26
  v_exp_f32 v27, v27
  v_add_f32 v24, 1.0, v24
  v_add_f32 v25, 1.0, v25
  v_add_f32 v26, 1.0, v26
  v_add_f32 v27, 1.0, v27
  v_rcp_f32 v24, v24
  v_rcp_f32 v25, v25
  v_rcp_f32 v26, v26
  v_rcp_f32 v27, v27
  v_mul_f32 v116, v116, v24
  v_mul_f32 v117, v117, v25
  v_mul_f32 v118, v118, v26
  v_mul_f32 v119, v119, v27
  v_cvt_pk_bf16_f32 v24, v116, v117
  v_lshlrev_b32 v44, 16, v24
  v_and_b32 v45, 0xffff0000, v24
  v_cvt_pk_bf16_f32 v26, v118, v119
  v_lshlrev_b32 v46, 16, v26
  v_and_b32 v47, 0xffff0000, v26
  v_add_f32 v33, v44, v45
  v_mul_f32 v37, v44, v44
  v_add_f32 v33, v33, v46
  v_fma_f32 v37, v45, v45, v37
  v_add_f32 v33, v33, v47
  v_fma_f32 v37, v46, v46, v37
  v_fma_f32 v37, v47, v47, v37
  v_cvt_pk_bf16_f32 v24, v120, v121
  v_lshlrev_b32 v120, 16, v24
  v_and_b32 v121, 0xffff0000, v24
  v_cvt_pk_bf16_f32 v26, v122, v123
  v_lshlrev_b32 v122, 16, v26
  v_and_b32 v123, 0xffff0000, v26
  v_mul_f32 v24, v120, v120
  v_mul_f32 v25, v121, v121
  v_mul_f32 v26, v122, v122
  v_mul_f32 v27, v123, v123
  v_fmaak_f32 v24, v2, v24, 0xc0135761
  v_fmaak_f32 v25, v2, v25, 0xc0135761
  v_fmaak_f32 v26, v2, v26, 0xc0135761
  v_fmaak_f32 v27, v2, v27, 0xc0135761
  v_mul_f32 v24, v24, v120
  v_mul_f32 v25, v25, v121
  v_mul_f32 v26, v26, v122
  v_mul_f32 v27, v27, v123
  v_exp_f32 v24, v24
  v_exp_f32 v25, v25
  v_exp_f32 v26, v26
  v_exp_f32 v27, v27
  v_add_f32 v24, 1.0, v24
  v_add_f32 v25, 1.0, v25
  v_add_f32 v26, 1.0, v26
  v_add_f32 v27, 1.0, v27
  v_rcp_f32 v24, v24
  v_rcp_f32 v25, v25
  v_rcp_f32 v26, v26
  v_rcp_f32 v27, v27
  v_mul_f32 v120, v120, v24
  v_mul_f32 v121, v121, v25
  v_mul_f32 v122, v122, v26
  v_mul_f32 v123, v123, v27
  v_cvt_pk_bf16_f32 v24, v120, v121
  v_lshlrev_b32 v48, 16, v24
  v_and_b32 v49, 0xffff0000, v24
  v_cvt_pk_bf16_f32 v26, v122, v123
  v_lshlrev_b32 v50, 16, v26
  v_and_b32 v51, 0xffff0000, v26
  v_add_f32 v34, v48, v49
  v_mul_f32 v38, v48, v48
  v_add_f32 v34, v34, v50
  v_fma_f32 v38, v49, v49, v38
  v_add_f32 v34, v34, v51
  v_fma_f32 v38, v50, v50, v38
  v_fma_f32 v38, v51, v51, v38
  v_cvt_pk_bf16_f32 v24, v124, v125
  v_lshlrev_b32 v124, 16, v24
  v_and_b32 v125, 0xffff0000, v24
  v_cvt_pk_bf16_f32 v26, v126, v127
  v_lshlrev_b32 v126, 16, v26
  v_and_b32 v127, 0xffff0000, v26
  v_mul_f32 v24, v124, v124
  v_mul_f32 v25, v125, v125
  v_mul_f32 v26, v126, v126
  v_mul_f32 v27, v127, v127
  v_fmaak_f32 v24, v2, v24, 0xc0135761
  v_fmaak_f32 v25, v2, v25, 0xc0135761
  v_fmaak_f32 v26, v2, v26, 0xc0135761
  v_fmaak_f32 v27, v2, v27, 0xc0135761
  v_mul_f32 v24, v24, v124
  v_mul_f32 v25, v25, v125
  v_mul_f32 v26, v26, v126
  v_mul_f32 v27, v27, v127
  v_exp_f32 v24, v24
  v_exp_f32 v25, v25
  v_exp_f32 v26, v26
  v_exp_f32 v27, v27
  v_add_f32 v24, 1.0, v24
  v_add_f32 v25, 1.0, v25
  v_add_f32 v26, 1.0, v26
  v_add_f32 v27, 1.0, v27
  v_rcp_f32 v24, v24
  v_rcp_f32 v25, v25
  v_rcp_f32 v26, v26
  v_rcp_f32 v27, v27
  v_mul_f32 v124, v124, v24
  v_mul_f32 v125, v125, v25
  v_mul_f32 v126, v126, v26
  v_mul_f32 v127, v127, v27
  v_cvt_pk_bf16_f32 v24, v124, v125
  v_lshlrev_b32 v52, 16, v24
  v_and_b32 v53, 0xffff0000, v24
  v_cvt_pk_bf16_f32 v26, v126, v127
  v_lshlrev_b32 v54, 16, v26
  v_and_b32 v55, 0xffff0000, v26
  v_add_f32 v35, v52, v53
  v_mul_f32 v39, v52, v52
  v_add_f32 v35, v35, v54
  v_fma_f32 v39, v53, v53, v39
  v_add_f32 v35, v35, v55
  v_fma_f32 v39, v54, v54, v39
  v_fma_f32 v39, v55, v55, v39
  v_permlane32_swap_b32 v32, v36
  v_permlane32_swap_b32 v33, v37
  v_permlane32_swap_b32 v34, v38
  v_permlane32_swap_b32 v35, v39
  v_add_f32 v32, v32, v36
  v_add_f32 v33, v33, v37
  v_add_f32 v34, v34, v38
  v_add_f32 v35, v35, v39
  v_permlane16_swap_b32 v32, v33
  s_nop 0
  v_permlane16_swap_b32 v34, v35
  v_add_f32 v32, v32, v33
  v_add_f32 v34, v34, v35
  v_lshlrev_b32 v5, 2, v1
  s_lshl_b32 s50, s42, 9
  s_add_u32 s50, s50, 91648
  v_add_u32 v5, s50, v5
  ds_write_b32 v5, v32
  ds_write_b32 v5, v34 offset:256
  s_waitcnt lgkmcnt(0)
  s_barrier
  s_mov_b32 s60, 0
  s_branch L_WC1_CK
L_WC1_RE:
  s_add_u32 s60, s60, 1
  s_cmp_gt_u32 s60, 200000
  s_cbranch_scc1 L_WC1_OK
  v_mov_b32 v7, v30
  global_load_dwordx4 v[128:131], v7, s[40:41] offset:0 sc1
  global_load_dwordx4 v[132:135], v7, s[40:41] offset:1024 sc1
  global_load_dwordx4 v[136:139], v7, s[40:41] offset:2048 sc1
  global_load_dwordx4 v[140:143], v7, s[40:41] offset:3072 sc1
  v_add_u32 v7, 4096, v7
  global_load_dwordx4 v[144:147], v7, s[40:41] offset:0 sc1
  global_load_dwordx4 v[148:151], v7, s[40:41] offset:1024 sc1
  global_load_dwordx4 v[152:155], v7, s[40:41] offset:2048 sc1
  global_load_dwordx4 v[156:159], v7, s[40:41] offset:3072 sc1
  v_add_u32 v7, 4096, v7
  global_load_dwordx4 v[160:163], v7, s[40:41] offset:0 sc1
  global_load_dwordx4 v[164:167], v7, s[40:41] offset:1024 sc1
  global_load_dwordx4 v[168:171], v7, s[40:41] offset:2048 sc1
  global_load_dwordx4 v[172:175], v7, s[40:41] offset:3072 sc1
  v_add_u32 v7, 4096, v7
  global_load_dwordx4 v[176:179], v7, s[40:41] offset:0 sc1
  global_load_dwordx4 v[180:183], v7, s[40:41] offset:1024 sc1
  global_load_dwordx4 v[184:187], v7, s[40:41] offset:2048 sc1
  global_load_dwordx4 v[188:191], v7, s[40:41] offset:3072 sc1
  s_waitcnt vmcnt(0)
L_WC1_CK:
  v_max3_u32 v6, v128, v129, v130
  v_max3_u32 v6, v6, v131, v132
  v_max3_u32 v6, v6, v133, v134
  v_max3_u32 v6, v6, v135, v136
  v_max3_u32 v6, v6, v137, v138
  v_max3_u32 v6, v6, v139, v140
  v_max3_u32 v6, v6, v141, v142
  v_max3_u32 v6, v6, v143, v144
  v_max3_u32 v6, v6, v145, v146
  v_max3_u32 v6, v6, v147, v148
  v_max3_u32 v6, v6, v149, v150
  v_max3_u32 v6, v6, v151, v152
  v_max3_u32 v6, v6, v153, v154
  v_max3_u32 v6, v6, v155, v156
  v_max3_u32 v6, v6, v157, v158
  v_max3_u32 v6, v6, v159, v160
  v_max3_u32 v6, v6, v161, v162
  v_max3_u32 v6, v6, v163, v164
  v_max3_u32 v6, v6, v165, v166
  v_max3_u32 v6, v6, v167, v168
  v_max3_u32 v6, v6, v169, v170
  v_max3_u32 v6, v6, v171, v172
  v_max3_u32 v6, v6, v173, v174
  v_max3_u32 v6, v6, v175, v176
  v_max3_u32 v6, v6, v177, v178
  v_max3_u32 v6, v6, v179, v180
  v_max3_u32 v6, v6, v181, v182
  v_max3_u32 v6, v6, v183, v184
  v_max3_u32 v6, v6, v185, v186
  v_max3_u32 v6, v6, v187, v188
  v_max3_u32 v6, v6, v189, v190
  v_max_u32 v6, v6, v191
  v_cmp_eq_u32 vcc, -1, v6
  s_cbranch_vccnz L_WC1_RE
L_WC1_OK:
  ds_read_b128 v[64:67], v16 offset:0
  ds_read_b128 v[68:71], v17 offset:16384
  ds_read_b128 v[72:75], v18 offset:32768
  ds_read_b128 v[76:79], v19 offset:49152
  ds_read_b128 v[80:83], v18 offset:0
  ds_read_b128 v[84:87], v19 offset:16384
  ds_read_b128 v[88:91], v16 offset:32768
  ds_read_b128 v[92:95], v17 offset:49152
  ds_read_b128 v[96:99], v20 offset:0
  ds_read_b128 v[100:103], v21 offset:16384
  ds_read_b128 v[104:107], v22 offset:32768
  ds_read_b128 v[108:111], v23 offset:49152
  s_waitcnt lgkmcnt(8)
  v_mfma_f32_16x16x32_bf16 v[112:115], v[128:131], v[64:67], 0
  v_mfma_f32_16x16x32_bf16 v[116:119], v[128:131], v[68:71], 0
  v_mfma_f32_16x16x32_bf16 v[120:123], v[128:131], v[72:75], 0
  v_mfma_f32_16x16x32_bf16 v[124:127], v[128:131], v[76:79], 0
  v_add_u32 v10, 0, v9
  global_load_dwordx4 v[128:131], v10, s[40:41] offset:0 sc1
  ds_read_b128 v[64:67], v22 offset:0
  ds_read_b128 v[68:71], v23 offset:16384
  ds_read_b128 v[72:75], v20 offset:32768
  ds_read_b128 v[76:79], v21 offset:49152
  s_waitcnt lgkmcnt(8)
  v_mfma_f32_16x16x32_bf16 v[112:115], v[132:135], v[80:83], v[112:115]
  v_mfma_f32_16x16x32_bf16 v[116:119], v[132:135], v[84:87], v[116:119]
  v_mfma_f32_16x16x32_bf16 v[120:123], v[132:135], v[88:91], v[120:123]
  v_mfma_f32_16x16x32_bf16 v[124:127], v[132:135], v[92:95], v[124:127]
  global_load_dwordx4 v[132:135], v10, s[40:41] offset:1024 sc1
  ds_read_b128 v[80:83], v16 offset:256
  ds_read_b128 v[84:87], v17 offset:16640
  ds_read_b128 v[88:91], v18 offset:33024
  ds_read_b128 v[92:95], v19 offset:49408
  s_waitcnt lgkmcnt(8)
  v_mfma_f32_16x16x32_bf16 v[112:115], v[136:139], v[96:99], v[112:115]
  v_mfma_f32_16x16x32_bf16 v[116:119], v[136:139], v[100:103], v[116:119]
  v_mfma_f32_16x16x32_bf16 v[120:123], v[136:139], v[104:107], v[120:123]
  v_mfma_f32_16x16x32_bf16 v[124:127], v[136:139], v[108:111], v[124:127]
  global_load_dwordx4 v[136:139], v10, s[40:41] offset:2048 sc1
  ds_read_b128 v[96:99], v18 offset:256
  ds_read_b128 v[100:103], v19 offset:16640
  ds_read_b128 v[104:107], v16 offset:33024
  ds_read_b128 v[108:111], v17 offset:49408
  s_waitcnt lgkmcnt(8)
  v_mfma_f32_16x16x32_bf16 v[112:115], v[140:143], v[64:67], v[112:115]
  v_mfma_f32_16x16x32_bf16 v[116:119], v[140:143], v[68:71], v[116:119]
  v_mfma_f32_16x16x32_bf16 v[120:123], v[140:143], v[72:75], v[120:123]
  v_mfma_f32_16x16x32_bf16 v[124:127], v[140:143], v[76:79], v[124:127]
  global_load_dwordx4 v[140:143], v10, s[40:41] offset:3072 sc1
  ds_read_b128 v[64:67], v20 offset:256
  ds_read_b128 v[68:71], v21 offset:16640
  ds_read_b128 v[72:75], v22 offset:33024
  ds_read_b128 v[76:79], v23 offset:49408
  s_waitcnt lgkmcnt(8)
  v_mfma_f32_16x16x32_bf16 v[112:115], v[144:147], v[80:83], v[112:115]
  v_mfma_f32_16x16x32_bf16 v[116:119], v[144:147], v[84:87], v[116:119]
  v_mfma_f32_16x16x32_bf16 v[120:123], v[144:147], v[88:91], v[120:123]
  v_mfma_f32_16x16x32_bf16 v[124:127], v[144:147], v[92:95], v[124:127]
  v_add_u32 v10, 4096, v9
  global_load_dwordx4 v[144:147], v10, s[40:41] offset:0 sc1
  ds_read_b128 v[80:83], v22 offset:256
  ds_read_b128 v[84:87], v23 offset:16640
  ds_read_b128 v[88:91], v20 offset:33024
  ds_read_b128 v[92:95], v21 offset:49408
  s_waitcnt lgkmcnt(8)
  v_mfma_f32_16x16x32_bf16 v[112:115], v[148:151], v[96:99], v[112:115]
  v_mfma_f32_16x16x32_bf16 v[116:119], v[148:151], v[100:103], v[116:119]
  v_mfma_f32_16x16x32_bf16 v[120:123], v[148:151], v[104:107], v[120:123]
  v_mfma_f32_16x16x32_bf16 v[124:127], v[148:151], v[108:111], v[124:127]
  global_load_dwordx4 v[148:151], v10, s[40:41] offset:1024 sc1
  ds_read_b128 v[96:99], v16 offset:512
  ds_read_b128 v[100:103], v17 offset:16896
  ds_read_b128 v[104:107], v18 offset:33280
  ds_read_b128 v[108:111], v19 offset:49664
  s_waitcnt lgkmcnt(8)
  v_mfma_f32_16x16x32_bf16 v[112:115], v[152:155], v[64:67], v[112:115]
  v_mfma_f32_16x16x32_bf16 v[116:119], v[152:155], v[68:71], v[116:119]
  v_mfma_f32_16x16x32_bf16 v[120:123], v[152:155], v[72:75], v[120:123]
  v_mfma_f32_16x16x32_bf16 v[124:127], v[152:155], v[76:79], v[124:127]
  global_load_dwordx4 v[152:155], v10, s[40:41] offset:2048 sc1
  ds_read_b128 v[64:67], v18 offset:512
  ds_read_b128 v[68:71], v19 offset:16896
  ds_read_b128 v[72:75], v16 offset:33280
  ds_read_b128 v[76:79], v17 offset:49664
  s_waitcnt lgkmcnt(8)
  v_mfma_f32_16x16x32_bf16 v[112:115], v[156:159], v[80:83], v[112:115]
  v_mfma_f32_16x16x32_bf16 v[116:119], v[156:159], v[84:87], v[116:119]
  v_mfma_f32_16x16x32_bf16 v[120:123], v[156:159], v[88:91], v[120:123]
  v_mfma_f32_16x16x32_bf16 v[124:127], v[156:159], v[92:95], v[124:127]
  global_load_dwordx4 v[156:159], v10, s[40:41] offset:3072 sc1
  ds_read_b128 v[80:83], v20 offset:512
  ds_read_b128 v[84:87], v21 offset:16896
  ds_read_b128 v[88:91], v22 offset:33280
  ds_read_b128 v[92:95], v23 offset:49664
  s_waitcnt lgkmcnt(8)
  v_mfma_f32_16x16x32_bf16 v[112:115], v[160:163], v[96:99], v[112:115]
  v_mfma_f32_16x16x32_bf16 v[116:119], v[160:163], v[100:103], v[116:119]
  v_mfma_f32_16x16x32_bf16 v[120:123], v[160:163], v[104:107], v[120:123]
  v_mfma_f32_16x16x32_bf16 v[124:127], v[160:163], v[108:111], v[124:127]
  v_add_u32 v10, 8192, v9
  global_load_dwordx4 v[160:163], v10, s[40:41] offset:0 sc1
  ds_read_b128 v[96:99], v22 offset:512
  ds_read_b128 v[100:103], v23 offset:16896
  ds_read_b128 v[104:107], v20 offset:33280
  ds_read_b128 v[108:111], v21 offset:49664
  s_waitcnt lgkmcnt(8)
  v_mfma_f32_16x16x32_bf16 v[112:115], v[164:167], v[64:67], v[112:115]
  v_mfma_f32_16x16x32_bf16 v[116:119], v[164:167], v[68:71], v[116:119]
  v_mfma_f32_16x16x32_bf16 v[120:123], v[164:167], v[72:75], v[120:123]
  v_mfma_f32_16x16x32_bf16 v[124:127], v[164:167], v[76:79], v[124:127]
  global_load_dwordx4 v[164:167], v10, s[40:41] offset:1024 sc1
  ds_read_b128 v[64:67], v16 offset:768
  ds_read_b128 v[68:71], v17 offset:17152
  ds_read_b128 v[72:75], v18 offset:33536
  ds_read_b128 v[76:79], v19 offset:49920
  s_waitcnt lgkmcnt(8)
  v_mfma_f32_16x16x32_bf16 v[112:115], v[168:171], v[80:83], v[112:115]
  v_mfma_f32_16x16x32_bf16 v[116:119], v[168:171], v[84:87], v[116:119]
  v_mfma_f32_16x16x32_bf16 v[120:123], v[168:171], v[88:91], v[120:123]
  v_mfma_f32_16x16x32_bf16 v[124:127], v[168:171], v[92:95], v[124:127]
  global_load_dwordx4 v[168:171], v10, s[40:41] offset:2048 sc1
  ds_read_b128 v[80:83], v18 offset:768
  ds_read_b128 v[84:87], v19 offset:17152
  ds_read_b128 v[88:91], v16 offset:33536
  ds_read_b128 v[92:95], v17 offset:49920
  s_waitcnt lgkmcnt(8)
  v_mfma_f32_16x16x32_bf16 v[112:115], v[172:175], v[96:99], v[112:115]
  v_mfma_f32_16x16x32_bf16 v[116:119], v[172:175], v[100:103], v[116:119]
  v_mfma_f32_16x16x32_bf16 v[120:123], v[172:175], v[104:107], v[120:123]
  v_mfma_f32_16x16x32_bf16 v[124:127], v[172:175], v[108:111], v[124:127]
  global_load_dwordx4 v[172:175], v10, s[40:41] offset:3072 sc1
  ds_read_b128 v[96:99], v20 offset:768
  ds_read_b128 v[100:103], v21 offset:17152
  ds_read_b128 v[104:107], v22 offset:33536
  ds_read_b128 v[108:111], v23 offset:49920
  s_waitcnt lgkmcnt(8)
  v_mfma_f32_16x16x32_bf16 v[112:115], v[176:179], v[64:67], v[112:115]
  v_mfma_f32_16x16x32_bf16 v[116:119], v[176:179], v[68:71], v[116:119]
  v_mfma_f32_16x16x32_bf16 v[120:123], v[176:179], v[72:75], v[120:123]
  v_mfma_f32_16x16x32_bf16 v[124:127], v[176:179], v[76:79], v[124:127]
  v_add_u32 v10, 12288, v9
  global_load_dwordx4 v[176:179], v10, s[40:41] offset:0 sc1
  ds_read_b128 v[64:67], v22 offset:768
  ds_read_b128 v[68:71], v23 offset:17152
  ds_read_b128 v[72:75], v20 offset:33536
  ds_read_b128 v[76:79], v21 offset:49920
  s_waitcnt lgkmcnt(8)
  v_mfma_f32_16x16x32_bf16 v[112:115], v[180:183], v[80:83], v[112:115]
  v_mfma_f32_16x16x32_bf16 v[116:119], v[180:183], v[84:87], v[116:119]
  v_mfma_f32_16x16x32_bf16 v[120:123], v[180:183], v[88:91], v[120:123]
  v_mfma_f32_16x16x32_bf16 v[124:127], v[180:183], v[92:95], v[124:127]
  global_load_dwordx4 v[180:183], v10, s[40:41] offset:1024 sc1
  s_waitcnt lgkmcnt(4)
  v_mfma_f32_16x16x32_bf16 v[112:115], v[184:187], v[96:99], v[112:115]
  v_mfma_f32_16x16x32_bf16 v[116:119], v[184:187], v[100:103], v[116:119]
  v_mfma_f32_16x16x32_bf16 v[120:123], v[184:187], v[104:107], v[120:123]
  v_mfma_f32_16x16x32_bf16 v[124:127], v[184:187], v[108:111], v[124:127]
  global_load_dwordx4 v[184:187], v10, s[40:41] offset:2048 sc1
  s_waitcnt lgkmcnt(0)
  v_mfma_f32_16x16x32_bf16 v[112:115], v[188:191], v[64:67], v[112:115]
  v_mfma_f32_16x16x32_bf16 v[116:119], v[188:191], v[68:71], v[116:119]
  v_mfma_f32_16x16x32_bf16 v[120:123], v[188:191], v[72:75], v[120:123]
  v_mfma_f32_16x16x32_bf16 v[124:127], v[188:191], v[76:79], v[124:127]
  global_load_dwordx4 v[188:191], v10, s[40:41] offset:3072 sc1
  v_lshlrev_b32 v5, 3, v28
  v_add_u32 v5, 95744, v5
  s_mul_i32 s50, s42, 2560
  s_add_u32 s50, s50, 73728
  v_mul_u32_u24 v6, 40, v28
  v_lshl_add_u32 v6, v29, 3, v6
  v_add_u32 v6, s50, v6
  v_lshrrev_b32 v7, 2, v28
  v_lshl_add_u32 v7, v29, 3, v7
  v_mul_u32_u24 v7, 40, v7
  v_and_b32 v8, 3, v28
  v_lshl_add_u32 v7, v8, 3, v7
  v_add_u32 v7, s50, v7
  s_mul_i32 s50, s46, 7
  s_add_u32 s50, s50, s42
  s_lshl_b32 s50, s50, 6
  s_lshl_b32 s51, s45, 1
  s_add_u32 s50, s50, s51
  s_lshl_b32 s50, s50, 10
  s_add_u32 s50, s50, 2097152
  v_lshlrev_b32 v8, 4, v1
  v_add_u32 v8, s50, v8
  s_branch L_C_JOIN
L_C_W7A:
  v_lshlrev_b32 v5, 2, v1
  v_add_u32 v5, 91648, v5
  s_lshl_b32 s50, s45, 13
  s_add_u32 s50, s50, 19955712
  s_lshl_b32 s51, s46, 10
  s_add_u32 s51, s51, s50
  v_lshlrev_b32 v8, 4, v1
  v_add_u32 v6, s51, v8
  v_add_u32 v10, 0, v9
  global_load_dwordx4 v[128:131], v10, s[40:41] offset:0 sc1
  global_load_dwordx4 v[132:135], v10, s[40:41] offset:1024 sc1
  global_load_dwordx4 v[136:139], v10, s[40:41] offset:2048 sc1
  global_load_dwordx4 v[140:143], v10, s[40:41] offset:3072 sc1
  v_add_u32 v10, 4096, v9
  global_load_dwordx4 v[144:147], v10, s[40:41] offset:0 sc1
  global_load_dwordx4 v[148:151], v10, s[40:41] offset:1024 sc1
  global_load_dwordx4 v[152:155], v10, s[40:41] offset:2048 sc1
  global_load_dwordx4 v[156:159], v10, s[40:41] offset:3072 sc1
  v_add_u32 v10, 8192, v9
  global_load_dwordx4 v[160:163], v10, s[40:41] offset:0 sc1
  global_load_dwordx4 v[164:167], v10, s[40:41] offset:1024 sc1
  global_load_dwordx4 v[168:171], v10, s[40:41] offset:2048 sc1
  global_load_dwordx4 v[172:175], v10, s[40:41] offset:3072 sc1
  v_add_u32 v10, 12288, v9
  global_load_dwordx4 v[176:179], v10, s[40:41] offset:0 sc1
  global_load_dwordx4 v[180:183], v10, s[40:41] offset:1024 sc1
  global_load_dwordx4 v[184:187], v10, s[40:41] offset:2048 sc1
  global_load_dwordx4 v[188:191], v10, s[40:41] offset:3072 sc1
  v_add_u32 v10, 16384, v9
  global_load_dwordx4 v[192:195], v10, s[40:41] offset:0 sc1
  global_load_dwordx4 v[196:199], v10, s[40:41] offset:1024 sc1
  global_load_dwordx4 v[200:203], v10, s[40:41] offset:2048 sc1
  global_load_dwordx4 v[204:207], v10, s[40:41] offset:3072 sc1
  v_add_u32 v10, 20480, v9
  global_load_dwordx4 v[208:211], v10, s[40:41] offset:0 sc1
  global_load_dwordx4 v[212:215], v10, s[40:41] offset:1024 sc1
  global_load_dwordx4 v[216:219], v10, s[40:41] offset:2048 sc1
  global_load_dwordx4 v[220:223], v10, s[40:41] offset:3072 sc1
  v_add_u32 v10, 24576, v9
  global_load_dwordx4 v[224:227], v10, s[40:41] offset:0 sc1
  global_load_dwordx4 v[228:231], v10, s[40:41] offset:1024 sc1
  global_load_dwordx4 v[232:235], v10, s[40:41] offset:2048 sc1
  global_load_dwordx4 v[236:239], v10, s[40:41] offset:3072 sc1
  v_add_u32 v10, 28672, v9
  global_load_dwordx4 v[240:243], v10, s[40:41] offset:0 sc1
  global_load_dwordx4 v[244:247], v10, s[40:41] offset:1024 sc1
  global_load_dwordx4 v[248:251], v10, s[40:41] offset:2048 sc1
  global_load_dwordx4 v[252:255], v10, s[40:41] offset:3072 sc1
  v_lshlrev_b32 v8, 4, v1
  v_add_u32 v9, s50, v8
  v_add_u32 v10, 4096, v9
  s_barrier
  ds_read_b32 v32, v5 offset:0
  ds_read_b32 v33, v5 offset:256
  ds_read_b32 v34, v5 offset:512
  ds_read_b32 v35, v5 offset:768
  ds_read_b32 v36, v5 offset:1024
  ds_read_b32 v37, v5 offset:1280
  ds_read_b32 v38, v5 offset:1536
  ds_read_b32 v39, v5 offset:1792
  ds_read_b32 v40, v5 offset:2048
  ds_read_b32 v41, v5 offset:2304
  ds_read_b32 v42, v5 offset:2560
  ds_read_b32 v43, v5 offset:2816
  ds_read_b32 v44, v5 offset:3072
  ds_read_b32 v45, v5 offset:3328
  s_waitcnt lgkmcnt(0)
  v_pk_add_f32 v[32:33], v[32:33], v[34:35]
  v_pk_add_f32 v[32:33], v[32:33], v[36:37]
  v_pk_add_f32 v[32:33], v[32:33], v[38:39]
  v_pk_add_f32 v[32:33], v[32:33], v[40:41]
  v_pk_add_f32 v[32:33], v[32:33], v[42:43]
  v_pk_add_f32 v[32:33], v[32:33], v[44:45]
  s_nop 1
  v_permlane32_swap_b32 v32, v33
  v_mov_b32 v34, v3
  v_mov_b32 v35, v3
  global_store_dwordx4 v6, v[32:35], s[40:41] sc1
  s_mov_b32 s60, 0
L_PZ:
  global_load_dwordx4 v[64:67], v9, s[40:41] offset:0 sc1
  global_load_dwordx4 v[68:71], v9, s[40:41] offset:1024 sc1
  global_load_dwordx4 v[72:75], v9, s[40:41] offset:2048 sc1
  global_load_dwordx4 v[76:79], v9, s[40:41] offset:3072 sc1
  global_load_dwordx4 v[80:83], v10, s[40:41] offset:0 sc1
  global_load_dwordx4 v[84:87], v10, s[40:41] offset:1024 sc1
  global_load_dwordx4 v[88:91], v10, s[40:41] offset:2048 sc1
  global_load_dwordx4 v[92:95], v10, s[40:41] offset:3072 sc1
  s_waitcnt vmcnt(0)
  v_xor_b32 v12, v3, v66
  v_xor_b32 v13, v3, v70
  v_or_b32 v12, v12, v13
  v_xor_b32 v13, v3, v74
  v_or_b32 v12, v12, v13
  v_xor_b32 v13, v3, v78
  v_or_b32 v12, v12, v13
  v_xor_b32 v13, v3, v82
  v_or_b32 v12, v12, v13
  v_xor_b32 v13, v3, v86
  v_or_b32 v12, v12, v13
  v_xor_b32 v13, v3, v90
  v_or_b32 v12, v12, v13
  v_xor_b32 v13, v3, v94
  v_or_b32 v12, v12, v13
  v_xor_b32 v13, v3, v67
  v_or_b32 v12, v12, v13
  v_xor_b32 v13, v3, v71
  v_or_b32 v12, v12, v13
  v_xor_b32 v13, v3, v75
  v_or_b32 v12, v12, v13
  v_xor_b32 v13, v3, v79
  v_or_b32 v12, v12, v13
  v_xor_b32 v13, v3, v83
  v_or_b32 v12, v12, v13
  v_xor_b32 v13, v3, v87
  v_or_b32 v12, v12, v13
  v_xor_b32 v13, v3, v91
  v_or_b32 v12, v12, v13
  v_xor_b32 v13, v3, v95
  v_or_b32 v12, v12, v13
  v_cmp_ne_u32 vcc, 0, v12
  s_add_u32 s60, s60, 1
  s_cmp_gt_u32 s60, 200000
  s_cbranch_scc1 L_PZ_X
  s_cbranch_vccnz L_PZ
L_PZ_X:
  v_pk_add_f32 v[64:65], v[64:65], v[68:69]
  v_pk_add_f32 v[64:65], v[64:65], v[72:73]
  v_pk_add_f32 v[64:65], v[64:65], v[76:77]
  v_pk_add_f32 v[64:65], v[64:65], v[80:81]
  v_pk_add_f32 v[64:65], v[64:65], v[84:85]
  v_pk_add_f32 v[64:65], v[64:65], v[88:89]
  v_pk_add_f32 v[64:65], v[64:65], v[92:93]
  v_mov_b32 v66, v65
  v_mul_f32 v64, 0x3a924925, v64
  v_mul_f32 v66, 0x3a924925, v66
  v_fma_f32 v66, -v64, v64, v66
  v_max_f32 v66, 0, v66
  v_cvt_pk_bf16_f32 v12, v64, v66
  v_lshlrev_b32 v64, 16, v12
  v_and_b32 v66, 0xffff0000, v12
  v_add_f32 v66, 0x3727c5ac, v66
  v_cvt_pk_bf16_f32 v12, v66, v66
  v_and_b32 v66, 0xffff0000, v12
  v_sqrt_f32 v66, v66
  s_nop 0
  v_cvt_pk_bf16_f32 v12, v66, v66
  v_and_b32 v66, 0xffff0000, v12
  v_rcp_f32 v12, v66
  s_nop 0
  v_mul_f32 v66, -v64, v12
  v_mov_b32 v64, v12
  v_mov_b32 v65, v66
  v_lshlrev_b32 v5, 3, v1
  v_add_u32 v5, 95744, v5
  ds_write_b64 v5, v[64:65]
L_C_JOIN:
  s_waitcnt lgkmcnt(0)
  s_barrier
  s_cmp_lt_u32 s42, 7
  s_cbranch_scc0 L_C_END
  ds_read_b64 v[32:33], v5 offset:0
  ds_read_b64 v[34:35], v5 offset:128
  ds_read_b64 v[36:37], v5 offset:256
  ds_read_b64 v[38:39], v5 offset:384
  s_waitcnt lgkmcnt(0)
  v_fma_f32 v40, v40, v32, v33
  v_fma_f32 v41, v41, v32, v33
  v_fma_f32 v42, v42, v32, v33
  v_fma_f32 v43, v43, v32, v33
  v_cvt_pk_bf16_f32 v40, v40, v41
  v_cvt_pk_bf16_f32 v41, v42, v43
  ds_write_b64 v6, v[40:41] offset:0
  v_fma_f32 v44, v44, v34, v35
  v_fma_f32 v45, v45, v34, v35
  v_fma_f32 v46, v46, v34, v35
  v_fma_f32 v47, v47, v34, v35
  v_cvt_pk_bf16_f32 v44, v44, v45
  v_cvt_pk_bf16_f32 v45, v46, v47
  ds_write_b64 v6, v[44:45] offset:640
  v_fma_f32 v48, v48, v36, v37
  v_fma_f32 v49, v49, v36, v37
  v_fma_f32 v50, v50, v36, v37
  v_fma_f32 v51, v51, v36, v37
  v_cvt_pk_bf16_f32 v48, v48, v49
  v_cvt_pk_bf16_f32 v49, v50, v51
  ds_write_b64 v6, v[48:49] offset:1280
  v_fma_f32 v52, v52, v38, v39
  v_fma_f32 v53, v53, v38, v39
  v_fma_f32 v54, v54, v38, v39
  v_fma_f32 v55, v55, v38, v39
  v_cvt_pk_bf16_f32 v52, v52, v53
  v_cvt_pk_bf16_f32 v53, v54, v55
  ds_write_b64 v6, v[52:53] offset:1920
  s_waitcnt lgkmcnt(0)
  ds_read_b64_tr_b16 v[64:65], v7 offset:0
  ds_read_b64_tr_b16 v[66:67], v7 offset:160
  ds_read_b64_tr_b16 v[68:69], v7 offset:1280
  ds_read_b64_tr_b16 v[70:71], v7 offset:1440
  s_waitcnt lgkmcnt(0)
  global_store_dwordx4 v8, v[64:67], s[40:41] sc1
  global_store_dwordx4 v8, v[68:71], s[40:41] offset:1024 sc1
  v_lshlrev_b32 v5, 3, v1
  s_lshl_b32 s50, s42, 11
  s_add_u32 s50, s50, 141312
  v_add_u32 v5, s50, v5
  v_cvt_pk_bf16_f32 v24, v112, v113
  v_lshlrev_b32 v112, 16, v24
  v_and_b32 v113, 0xffff0000, v24
  v_cvt_pk_bf16_f32 v26, v114, v115
  v_lshlrev_b32 v114, 16, v26
  v_and_b32 v115, 0xffff0000, v26
  v_mul_f32 v24, v112, v112
  v_mul_f32 v25, v113, v113
  v_mul_f32 v26, v114, v114
  v_mul_f32 v27, v115, v115
  v_fmaak_f32 v24, v2, v24, 0xc0135761
  v_fmaak_f32 v25, v2, v25, 0xc0135761
  v_fmaak_f32 v26, v2, v26, 0xc0135761
  v_fmaak_f32 v27, v2, v27, 0xc0135761
  v_mul_f32 v24, v24, v112
  v_mul_f32 v25, v25, v113
  v_mul_f32 v26, v26, v114
  v_mul_f32 v27, v27, v115
  v_exp_f32 v24, v24
  v_exp_f32 v25, v25
  v_exp_f32 v26, v26
  v_exp_f32 v27, v27
  v_add_f32 v24, 1.0, v24
  v_add_f32 v25, 1.0, v25
  v_add_f32 v26, 1.0, v26
  v_add_f32 v27, 1.0, v27
  v_rcp_f32 v24, v24
  v_rcp_f32 v25, v25
  v_rcp_f32 v26, v26
  v_rcp_f32 v27, v27
  v_mul_f32 v112, v112, v24
  v_mul_f32 v113, v113, v25
  v_mul_f32 v114, v114, v26
  v_mul_f32 v115, v115, v27
  v_cvt_pk_bf16_f32 v32, v112, v113
  v_cvt_pk_bf16_f32 v33, v114, v115
  ds_write_b64 v5, v[32:33] offset:0
  v_cvt_pk_bf16_f32 v24, v116, v117
  v_lshlrev_b32 v116, 16, v24
  v_and_b32 v117, 0xffff0000, v24
  v_cvt_pk_bf16_f32 v26, v118, v119
  v_lshlrev_b32 v118, 16, v26
  v_and_b32 v119, 0xffff0000, v26
  v_mul_f32 v24, v116, v116
  v_mul_f32 v25, v117, v117
  v_mul_f32 v26, v118, v118
  v_mul_f32 v27, v119, v119
  v_fmaak_f32 v24, v2, v24, 0xc0135761
  v_fmaak_f32 v25, v2, v25, 0xc0135761
  v_fmaak_f32 v26, v2, v26, 0xc0135761
  v_fmaak_f32 v27, v2, v27, 0xc0135761
  v_mul_f32 v24, v24, v116
  v_mul_f32 v25, v25, v117
  v_mul_f32 v26, v26, v118
  v_mul_f32 v27, v27, v119
  v_exp_f32 v24, v24
  v_exp_f32 v25, v25
  v_exp_f32 v26, v26
  v_exp_f32 v27, v27
  v_add_f32 v24, 1.0, v24
  v_add_f32 v25, 1.0, v25
  v_add_f32 v26, 1.0, v26
  v_add_f32 v27, 1.0, v27
  v_rcp_f32 v24, v24
  v_rcp_f32 v25, v25
  v_rcp_f32 v26, v26
  v_rcp_f32 v27, v27
  v_mul_f32 v116, v116, v24
  v_mul_f32 v117, v117, v25
  v_mul_f32 v118, v118, v26
  v_mul_f32 v119, v119, v27
  v_cvt_pk_bf16_f32 v34, v116, v117
  v_cvt_pk_bf16_f32 v35, v118, v119
  ds_write_b64 v5, v[34:35] offset:512
  v_cvt_pk_bf16_f32 v24, v120, v121
  v_lshlrev_b32 v120, 16, v24
  v_and_b32 v121, 0xffff0000, v24
  v_cvt_pk_bf16_f32 v26, v122, v123
  v_lshlrev_b32 v122, 16, v26
  v_and_b32 v123, 0xffff0000, v26
  v_mul_f32 v24, v120, v120
  v_mul_f32 v25, v121, v121
  v_mul_f32 v26, v122, v122
  v_mul_f32 v27, v123, v123
  v_fmaak_f32 v24, v2, v24, 0xc0135761
  v_fmaak_f32 v25, v2, v25, 0xc0135761
  v_fmaak_f32 v26, v2, v26, 0xc0135761
  v_fmaak_f32 v27, v2, v27, 0xc0135761
  v_mul_f32 v24, v24, v120
  v_mul_f32 v25, v25, v121
  v_mul_f32 v26, v26, v122
  v_mul_f32 v27, v27, v123
  v_exp_f32 v24, v24
  v_exp_f32 v25, v25
  v_exp_f32 v26, v26
  v_exp_f32 v27, v27
  v_add_f32 v24, 1.0, v24
  v_add_f32 v25, 1.0, v25
  v_add_f32 v26, 1.0, v26
  v_add_f32 v27, 1.0, v27
  v_rcp_f32 v24, v24
  v_rcp_f32 v25, v25
  v_rcp_f32 v26, v26
  v_rcp_f32 v27, v27
  v_mul_f32 v120, v120, v24
  v_mul_f32 v121, v121, v25
  v_mul_f32 v122, v122, v26
  v_mul_f32 v123, v123, v27
  v_cvt_pk_bf16_f32 v36, v120, v121
  v_cvt_pk_bf16_f32 v37, v122, v123
  ds_write_b64 v5, v[36:37] offset:1024
  v_cvt_pk_bf16_f32 v24, v124, v125
  v_lshlrev_b32 v124, 16, v24
  v_and_b32 v125, 0xffff0000, v24
  v_cvt_pk_bf16_f32 v26, v126, v127
  v_lshlrev_b32 v126, 16, v26
  v_and_b32 v127, 0xffff0000, v26
  v_mul_f32 v24, v124, v124
  v_mul_f32 v25, v125, v125
  v_mul_f32 v26, v126, v126
  v_mul_f32 v27, v127, v127
  v_fmaak_f32 v24, v2, v24, 0xc0135761
  v_fmaak_f32 v25, v2, v25, 0xc0135761
  v_fmaak_f32 v26, v2, v26, 0xc0135761
  v_fmaak_f32 v27, v2, v27, 0xc0135761
  v_mul_f32 v24, v24, v124
  v_mul_f32 v25, v25, v125
  v_mul_f32 v26, v26, v126
  v_mul_f32 v27, v27, v127
  v_exp_f32 v24, v24
  v_exp_f32 v25, v25
  v_exp_f32 v26, v26
  v_exp_f32 v27, v27
  v_add_f32 v24, 1.0, v24
  v_add_f32 v25, 1.0, v25
  v_add_f32 v26, 1.0, v26
  v_add_f32 v27, 1.0, v27
  v_rcp_f32 v24, v24
  v_rcp_f32 v25, v25
  v_rcp_f32 v26, v26
  v_rcp_f32 v27, v27
  v_mul_f32 v124, v124, v24
  v_mul_f32 v125, v125, v25
  v_mul_f32 v126, v126, v26
  v_mul_f32 v127, v127, v27
  v_cvt_pk_bf16_f32 v38, v124, v125
  v_cvt_pk_bf16_f32 v39, v126, v127
  ds_write_b64 v5, v[38:39] offset:1536
L_C_END:
  s_barrier
  s_mul_i32 s50, s46, 7
  s_lshl_b32 s50, s50, 6
  s_lshl_b32 s51, s42, 3
  s_add_u32 s50, s50, s51
  s_lshl_b32 s50, s50, 10
  s_add_u32 s50, s50, 2097152
  v_lshlrev_b32 v9, 4, v1
  v_add_u32 v9, s50, v9
  s_and_b32 s50, s45, 7
  s_mul_i32 s50, s50, 56
  s_mul_i32 s51, s42, 7
  s_add_u32 s50, s50, s51
  s_add_u32 s50, s50, 448
  s_lshl_b32 s50, s50, 10
  s_lshl_b32 s51, s46, 7
  s_add_u32 s50, s50, s51
  v_lshlrev_b32 v7, 10, v1
  v_add_u32 v7, s50, v7
  s_mov_b64 exec, 0x7f
  global_load_dword v7, v7, s[30:31]
  s_mov_b64 exec, -1
  v_add_u32 v2, 0, v9
  global_load_dwordx4 v[32:35], v2, s[40:41] offset:0 sc1
  global_load_dwordx4 v[36:39], v2, s[40:41] offset:1024 sc1
  global_load_dwordx4 v[40:43], v2, s[40:41] offset:2048 sc1
  global_load_dwordx4 v[44:47], v2, s[40:41] offset:3072 sc1
  v_add_u32 v2, 4096, v9
  global_load_dwordx4 v[48:51], v2, s[40:41] offset:0 sc1
  global_load_dwordx4 v[52:55], v2, s[40:41] offset:1024 sc1
  global_load_dwordx4 v[56:59], v2, s[40:41] offset:2048 sc1
  global_load_dwordx4 v[60:63], v2, s[40:41] offset:3072 sc1
  s_barrier
  v_add_u32 v2, 65536, v9
  global_load_dwordx4 v[64:67], v2, s[40:41] offset:0 sc1
  global_load_dwordx4 v[68:71], v2, s[40:41] offset:1024 sc1
  global_load_dwordx4 v[72:75], v2, s[40:41] offset:2048 sc1
  global_load_dwordx4 v[76:79], v2, s[40:41] offset:3072 sc1
  v_add_u32 v2, 69632, v9
  global_load_dwordx4 v[80:83], v2, s[40:41] offset:0 sc1
  global_load_dwordx4 v[84:87], v2, s[40:41] offset:1024 sc1
  global_load_dwordx4 v[88:91], v2, s[40:41] offset:2048 sc1
  global_load_dwordx4 v[92:95], v2, s[40:41] offset:3072 sc1
  v_lshrrev_b32 v16, 3, v1
  v_and_b32 v17, 7, v1
  v_lshrrev_b32 v18, 1, v17
  v_bfe_u32 v19, v16, 1, 2
  v_xor_b32 v18, v18, v19
  v_lshlrev_b32 v18, 1, v18
  v_and_b32 v19, 1, v17
  v_add_u32 v18, v18, v19
  v_lshlrev_b32 v18, 4, v18
  v_lshl_add_u32 v18, v16, 10, v18
  s_mul_i32 s50, s42, 57344
  s_lshl_b32 s51, s46, 7
  s_add_u32 s50, s50, s51
  v_add_u32 v18, s50, v18
  s_mul_i32 s51, s42, 7168
  s_add_u32 m0, s51, 65536
  s_nop 0
  global_load_lds_dwordx4 v18, s[30:31]
  v_add_u32 v18, 8192, v18
  s_add_u32 m0, s51, 66560
  s_nop 0
  global_load_lds_dwordx4 v18, s[30:31]
  v_add_u32 v18, 8192, v18
  s_add_u32 m0, s51, 67584
  s_nop 0
  global_load_lds_dwordx4 v18, s[30:31]
  v_add_u32 v18, 8192, v18
  s_add_u32 m0, s51, 68608
  s_nop 0
  global_load_lds_dwordx4 v18, s[30:31]
  v_add_u32 v18, 8192, v18
  s_add_u32 m0, s51, 69632
  s_nop 0
  global_load_lds_dwordx4 v18, s[30:31]
  v_add_u32 v18, 8192, v18
  s_add_u32 m0, s51, 70656
  s_nop 0
  global_load_lds_dwordx4 v18, s[30:31]
  v_add_u32 v18, 8192, v18
  s_add_u32 m0, s51, 71680
  s_nop 0
  global_load_lds_dwordx4 v18, s[30:31]
  v_and_b32 v5, 63, v0
  s_lshl_b32 s50, s46, 6
  v_add_u32 v5, s50, v5
  v_lshlrev_b32 v5, 5, v5
  v_add_u32 v5, 20332544, v5
  global_load_dwordx4 v[96:99], v5, s[40:41] sc1
  global_load_dwordx4 v[100:103], v5, s[40:41] offset:16 sc1
  v_bfe_u32 v6, v1, 1, 4
  s_lshl_b32 s50, s45, 6
  s_and_b32 s51, s42, 3
  s_lshl_b32 s51, s51, 4
  s_add_u32 s50, s50, s51
  v_add_u32 v4, s50, v6
  v_lshlrev_b32 v4, 1, v4
  global_load_ushort v8, v4, s[28:29]
  v_lshlrev_b32 v12, 4, v1
  s_lshl_b32 s50, s42, 12
  v_add_u32 v13, s50, v12
  s_lshr_b32 s57, s42, 2
  s_and_b32 s50, s42, 3
  s_lshl_b32 s50, s50, 10
  s_lshl_b32 s51, s57, 9
  s_add_u32 s50, s50, s51
  v_lshlrev_b32 v14, 3, v1
  v_add_u32 v14, s50, v14
  s_and_b32 s50, s42, 3
  s_lshl_b32 s50, s50, 9
  s_lshl_b32 s51, s57, 8
  s_add_u32 s50, s50, s51
  s_add_u32 s50, s50, 141312
  v_lshlrev_b32 v15, 2, v1
  v_add_u32 v15, s50, v15
  s_lshl_b32 s50, s45, 2
  s_and_b32 s51, s42, 3
  s_add_u32 s50, s50, s51
  s_mul_i32 s50, s50, 28
  s_lshl_b32 s50, s50, 10
  s_add_u32 s50, s50, 5767168
  s_lshl_b32 s51, s57, 9
  s_add_u32 s50, s50, s51
  v_lshrrev_b32 v12, 1, v1
  v_lshlrev_b32 v12, 4, v12
  v_and_b32 v6, 1, v1
  v_lshl_add_u32 v12, v6, 2, v12
  v_add_u32 v12, s50, v12
  s_mul_i32 s56, s46, 7
  s_waitcnt vmcnt(18)
  s_mov_b32 s60, 0
  s_branch L_D0_CK
L_D0_RE:
  s_add_u32 s60, s60, 1
  s_cmp_gt_u32 s60, 200000
  s_cbranch_scc1 L_D0_OK
  v_add_u32 v2, 0, v9
  global_load_dwordx4 v[32:35], v2, s[40:41] offset:0 sc1
  global_load_dwordx4 v[36:39], v2, s[40:41] offset:1024 sc1
  global_load_dwordx4 v[40:43], v2, s[40:41] offset:2048 sc1
  global_load_dwordx4 v[44:47], v2, s[40:41] offset:3072 sc1
  v_add_u32 v2, 4096, v9
  global_load_dwordx4 v[48:51], v2, s[40:41] offset:0 sc1
  global_load_dwordx4 v[52:55], v2, s[40:41] offset:1024 sc1
  global_load_dwordx4 v[56:59], v2, s[40:41] offset:2048 sc1
  global_load_dwordx4 v[60:63], v2, s[40:41] offset:3072 sc1
  s_waitcnt vmcnt(0)
L_D0_CK:
  v_max3_u32 v4, v32, v33, v34
  v_max3_u32 v4, v4, v35, v36
  v_max3_u32 v4, v4, v37, v38
  v_max3_u32 v4, v4, v39, v40
  v_max3_u32 v4, v4, v41, v42
  v_max3_u32 v4, v4, v43, v44
  v_max3_u32 v4, v4, v45, v46
  v_max3_u32 v4, v4, v47, v48
  v_max3_u32 v4, v4, v49, v50
  v_max3_u32 v4, v4, v51, v52
  v_max3_u32 v4, v4, v53, v54
  v_max3_u32 v4, v4, v55, v56
  v_max3_u32 v4, v4, v57, v58
  v_max3_u32 v4, v4, v59, v60
  v_max3_u32 v4, v4, v61, v62
  v_max_u32 v4, v4, v63
  v_cmp_eq_u32 vcc, -1, v4
  s_cbranch_vccnz L_D0_RE
L_D0_OK:
  s_mov_b32 s70, s60
  v_mfma_f32_16x16x32_bf16 v[16:19], v[32:35], v[128:131], 0
  v_mfma_f32_16x16x32_bf16 v[20:23], v[32:35], v[160:163], 0
  v_mfma_f32_16x16x32_bf16 v[24:27], v[32:35], v[192:195], 0
  v_mfma_f32_16x16x32_bf16 v[28:31], v[32:35], v[224:227], 0
  v_add_u32 v2, 131072, v9
  global_load_dwordx4 v[32:35], v2, s[40:41] offset:0 sc1
  v_mfma_f32_16x16x32_bf16 v[16:19], v[36:39], v[132:135], v[16:19]
  v_mfma_f32_16x16x32_bf16 v[20:23], v[36:39], v[164:167], v[20:23]
  v_mfma_f32_16x16x32_bf16 v[24:27], v[36:39], v[196:199], v[24:27]
  v_mfma_f32_16x16x32_bf16 v[28:31], v[36:39], v[228:231], v[28:31]
  global_load_dwordx4 v[36:39], v2, s[40:41] offset:1024 sc1
  v_mfma_f32_16x16x32_bf16 v[16:19], v[40:43], v[136:139], v[16:19]
  v_mfma_f32_16x16x32_bf16 v[20:23], v[40:43], v[168:171], v[20:23]
  v_mfma_f32_16x16x32_bf16 v[24:27], v[40:43], v[200:203], v[24:27]
  v_mfma_f32_16x16x32_bf16 v[28:31], v[40:43], v[232:235], v[28:31]
  global_load_dwordx4 v[40:43], v2, s[40:41] offset:2048 sc1
  v_mfma_f32_16x16x32_bf16 v[16:19], v[44:47], v[140:143], v[16:19]
  v_mfma_f32_16x16x32_bf16 v[20:23], v[44:47], v[172:175], v[20:23]
  v_mfma_f32_16x16x32_bf16 v[24:27], v[44:47], v[204:207], v[24:27]
  v_mfma_f32_16x16x32_bf16 v[28:31], v[44:47], v[236:239], v[28:31]
  global_load_dwordx4 v[44:47], v2, s[40:41] offset:3072 sc1
  s_waitcnt vmcnt(14)
  v_mfma_f32_16x16x32_bf16 v[16:19], v[48:51], v[144:147], v[16:19]
  v_max3_u32 v4, v64, v65, v66
  v_mfma_f32_16x16x32_bf16 v[20:23], v[48:51], v[176:179], v[20:23]
  v_max3_u32 v4, v4, v67, v68
  v_mfma_f32_16x16x32_bf16 v[24:27], v[48:51], v[208:211], v[24:27]
  v_max3_u32 v4, v4, v69, v70
  v_mfma_f32_16x16x32_bf16 v[28:31], v[48:51], v[240:243], v[28:31]
  v_max3_u32 v4, v4, v71, v72
  v_add_u32 v2, 135168, v9
  global_load_dwordx4 v[48:51], v2, s[40:41] offset:0 sc1
  v_mfma_f32_16x16x32_bf16 v[16:19], v[52:55], v[148:151], v[16:19]
  v_max3_u32 v4, v4, v73, v74
  v_mfma_f32_16x16x32_bf16 v[20:23], v[52:55], v[180:183], v[20:23]
  v_max3_u32 v4, v4, v75, v76
  v_mfma_f32_16x16x32_bf16 v[24:27], v[52:55], v[212:215], v[24:27]
  v_max3_u32 v4, v4, v77, v78
  v_mfma_f32_16x16x32_bf16 v[28:31], v[52:55], v[244:247], v[28:31]
  v_max3_u32 v4, v4, v79, v80
  global_load_dwordx4 v[52:55], v2, s[40:41] offset:1024 sc1
  v_mfma_f32_16x16x32_bf16 v[16:19], v[56:59], v[152:155], v[16:19]
  v_max3_u32 v4, v4, v81, v82
  v_mfma_f32_16x16x32_bf16 v[20:23], v[56:59], v[184:187], v[20:23]
  v_max3_u32 v4, v4, v83, v84
  v_mfma_f32_16x16x32_bf16 v[24:27], v[56:59], v[216:219], v[24:27]
  v_max3_u32 v4, v4, v85, v86
  v_mfma_f32_16x16x32_bf16 v[28:31], v[56:59], v[248:251], v[28:31]
  v_max3_u32 v4, v4, v87, v88
  global_load_dwordx4 v[56:59], v2, s[40:41] offset:2048 sc1
  v_mfma_f32_16x16x32_bf16 v[16:19], v[60:63], v[156:159], v[16:19]
  v_max3_u32 v4, v4, v89, v90
  v_mfma_f32_16x16x32_bf16 v[20:23], v[60:63], v[188:191], v[20:23]
  v_max3_u32 v4, v4, v91, v92
  v_mfma_f32_16x16x32_bf16 v[24:27], v[60:63], v[220:223], v[24:27]
  v_max3_u32 v4, v4, v93, v94
  v_mfma_f32_16x16x32_bf16 v[28:31], v[60:63], v[252:255], v[28:31]
  v_max_u32 v4, v4, v95
  global_load_dwordx4 v[60:63], v2, s[40:41] offset:3072 sc1
  v_cmp_eq_u32 vcc, -1, v4
  s_mov_b64 s[64:65], vcc
  s_waitcnt lgkmcnt(0)
  s_barrier
  s_waitcnt vmcnt(8)
  v_lshlrev_b32 v8, 16, v8
  v_xor_b32 v104, v3, v97
  v_xor_b32 v105, v3, v99
  v_or_b32 v104, v104, v105
  v_xor_b32 v105, v3, v101
  v_or_b32 v104, v104, v105
  v_xor_b32 v105, v3, v103
  v_or_b32 v104, v104, v105
  v_cmp_ne_u32 vcc, 0, v104
  s_cbranch_vccz L_GB_OK
  s_mov_b32 s60, 0
L_PGB:
  global_load_dwordx4 v[96:99], v5, s[40:41] sc1
  global_load_dwordx4 v[100:103], v5, s[40:41] offset:16 sc1
  s_waitcnt vmcnt(0)
  v_xor_b32 v104, v3, v97
  v_xor_b32 v105, v3, v99
  v_or_b32 v104, v104, v105
  v_xor_b32 v105, v3, v101
  v_or_b32 v104, v104, v105
  v_xor_b32 v105, v3, v103
  v_or_b32 v104, v104, v105
  v_cmp_ne_u32 vcc, 0, v104
  s_add_u32 s60, s60, 1
  s_cmp_gt_u32 s60, 200000
  s_cbranch_scc1 L_PGB_X
  s_cbranch_vccnz L_PGB
L_PGB_X:
L_GB_OK:
  v_add_f32 v96, v96, v98
  v_add_f32 v100, v100, v102
  v_add_f32 v96, v96, v100
  v_cvt_pk_bf16_f32 v96, v96, v96
  v_and_b32 v96, 0xffff0000, v96
  v_and_b32 v7, 63, v0
  v_lshlrev_b32 v7, 2, v7
  v_add_u32 v7, 140288, v7
  ds_write_b32 v7, v96
  s_cmp_eq_u64 s[64:65], 0
  s_cbranch_scc1 L_D1_OK2
  s_mov_b32 s60, 0
  s_branch L_D1_CK
L_D1_RE:
  s_add_u32 s60, s60, 1
  s_cmp_gt_u32 s60, 200000
  s_cbranch_scc1 L_D1_OK
  v_add_u32 v2, 65536, v9
  global_load_dwordx4 v[64:67], v2, s[40:41] offset:0 sc1
  global_load_dwordx4 v[68:71], v2, s[40:41] offset:1024 sc1
  global_load_dwordx4 v[72:75], v2, s[40:41] offset:2048 sc1
  global_load_dwordx4 v[76:79], v2, s[40:41] offset:3072 sc1
  v_add_u32 v2, 69632, v9
  global_load_dwordx4 v[80:83], v2, s[40:41] offset:0 sc1
  global_load_dwordx4 v[84:87], v2, s[40:41] offset:1024 sc1
  global_load_dwordx4 v[88:91], v2, s[40:41] offset:2048 sc1
  global_load_dwordx4 v[92:95], v2, s[40:41] offset:3072 sc1
  s_waitcnt vmcnt(0)
L_D1_CK:
  v_max3_u32 v4, v64, v65, v66
  v_max3_u32 v4, v4, v67, v68
  v_max3_u32 v4, v4, v69, v70
  v_max3_u32 v4, v4, v71, v72
  v_max3_u32 v4, v4, v73, v74
  v_max3_u32 v4, v4, v75, v76
  v_max3_u32 v4, v4, v77, v78
  v_max3_u32 v4, v4, v79, v80
  v_max3_u32 v4, v4, v81, v82
  v_max3_u32 v4, v4, v83, v84
  v_max3_u32 v4, v4, v85, v86
  v_max3_u32 v4, v4, v87, v88
  v_max3_u32 v4, v4, v89, v90
  v_max3_u32 v4, v4, v91, v92
  v_max3_u32 v4, v4, v93, v94
  v_max_u32 v4, v4, v95
  v_cmp_eq_u32 vcc, -1, v4
  s_cbranch_vccnz L_D1_RE
L_D1_OK:
L_D1_OK2:
  v_mfma_f32_16x16x32_bf16 v[112:115], v[64:67], v[128:131], 0
  v_mfma_f32_16x16x32_bf16 v[116:119], v[64:67], v[160:163], 0
  v_mfma_f32_16x16x32_bf16 v[120:123], v[64:67], v[192:195], 0
  v_mfma_f32_16x16x32_bf16 v[124:127], v[64:67], v[224:227], 0
  v_add_u32 v2, 196608, v9
  global_load_dwordx4 v[64:67], v2, s[40:41] offset:0 sc1
  v_mfma_f32_16x16x32_bf16 v[112:115], v[68:71], v[132:135], v[112:115]
  v_mfma_f32_16x16x32_bf16 v[116:119], v[68:71], v[164:167], v[116:119]
  v_mfma_f32_16x16x32_bf16 v[120:123], v[68:71], v[196:199], v[120:123]
  v_mfma_f32_16x16x32_bf16 v[124:127], v[68:71], v[228:231], v[124:127]
  global_load_dwordx4 v[68:71], v2, s[40:41] offset:1024 sc1
  v_mfma_f32_16x16x32_bf16 v[112:115], v[72:75], v[136:139], v[112:115]
  ds_write_b128 v13, v[16:19] offset:0
  v_mfma_f32_16x16x32_bf16 v[116:119], v[72:75], v[168:171], v[116:119]
  v_mfma_f32_16x16x32_bf16 v[120:123], v[72:75], v[200:203], v[120:123]
  ds_write_b128 v13, v[20:23] offset:1024
  v_mfma_f32_16x16x32_bf16 v[124:127], v[72:75], v[232:235], v[124:127]
  global_load_dwordx4 v[72:75], v2, s[40:41] offset:2048 sc1
  v_mfma_f32_16x16x32_bf16 v[112:115], v[76:79], v[140:143], v[112:115]
  ds_write_b128 v13, v[24:27] offset:2048
  v_mfma_f32_16x16x32_bf16 v[116:119], v[76:79], v[172:175], v[116:119]
  v_mfma_f32_16x16x32_bf16 v[120:123], v[76:79], v[204:207], v[120:123]
  ds_write_b128 v13, v[28:31] offset:3072
  v_mfma_f32_16x16x32_bf16 v[124:127], v[76:79], v[236:239], v[124:127]
  global_load_dwordx4 v[76:79], v2, s[40:41] offset:3072 sc1
  s_waitcnt vmcnt(4)
  v_mfma_f32_16x16x32_bf16 v[112:115], v[80:83], v[144:147], v[112:115]
  v_max3_u32 v4, v32, v33, v34
  v_mfma_f32_16x16x32_bf16 v[116:119], v[80:83], v[176:179], v[116:119]
  v_max3_u32 v4, v4, v35, v36
  v_mfma_f32_16x16x32_bf16 v[120:123], v[80:83], v[208:211], v[120:123]
  v_max3_u32 v4, v4, v37, v38
  v_mfma_f32_16x16x32_bf16 v[124:127], v[80:83], v[240:243], v[124:127]
  v_max3_u32 v4, v4, v39, v40
  v_add_u32 v2, 200704, v9
  global_load_dwordx4 v[80:83], v2, s[40:41] offset:0 sc1
  v_mfma_f32_16x16x32_bf16 v[112:115], v[84:87], v[148:151], v[112:115]
  v_max3_u32 v4, v4, v41, v42
  v_mfma_f32_16x16x32_bf16 v[116:119], v[84:87], v[180:183], v[116:119]
  v_max3_u32 v4, v4, v43, v44
  v_mfma_f32_16x16x32_bf16 v[120:123], v[84:87], v[212:215], v[120:123]
  v_max3_u32 v4, v4, v45, v46
  v_mfma_f32_16x16x32_bf16 v[124:127], v[84:87], v[244:247], v[124:127]
  v_max3_u32 v4, v4, v47, v48
  global_load_dwordx4 v[84:87], v2, s[40:41] offset:1024 sc1
  v_mfma_f32_16x16x32_bf16 v[112:115], v[88:91], v[152:155], v[112:115]
  v_max3_u32 v4, v4, v49, v50
  v_mfma_f32_16x16x32_bf16 v[116:119], v[88:91], v[184:187], v[116:119]
  v_max3_u32 v4, v4, v51, v52
  v_mfma_f32_16x16x32_bf16 v[120:123], v[88:91], v[216:219], v[120:123]
  v_max3_u32 v4, v4, v53, v54
  v_mfma_f32_16x16x32_bf16 v[124:127], v[88:91], v[248:251], v[124:127]
  v_max3_u32 v4, v4, v55, v56
  global_load_dwordx4 v[88:91], v2, s[40:41] offset:2048 sc1
  v_mfma_f32_16x16x32_bf16 v[112:115], v[92:95], v[156:159], v[112:115]
  v_max3_u32 v4, v4, v57, v58
  v_mfma_f32_16x16x32_bf16 v[116:119], v[92:95], v[188:191], v[116:119]
  v_max3_u32 v4, v4, v59, v60
  v_mfma_f32_16x16x32_bf16 v[120:123], v[92:95], v[220:223], v[120:123]
  v_max3_u32 v4, v4, v61, v62
  v_mfma_f32_16x16x32_bf16 v[124:127], v[92:95], v[252:255], v[124:127]
  v_max_u32 v4, v4, v63
  global_load_dwordx4 v[92:95], v2, s[40:41] offset:3072 sc1
  v_cmp_eq_u32 vcc, -1, v4
  s_mov_b64 s[64:65], vcc
  s_waitcnt lgkmcnt(0)
  s_barrier
  s_cmp_eq_u64 s[64:65], 0
  s_cbranch_scc1 L_D2_OK2
  s_mov_b32 s60, 0
  s_branch L_D2_CK
L_D2_RE:
  s_add_u32 s60, s60, 1
  s_cmp_gt_u32 s60, 200000
  s_cbranch_scc1 L_D2_OK
  v_add_u32 v2, 131072, v9
  global_load_dwordx4 v[32:35], v2, s[40:41] offset:0 sc1
  global_load_dwordx4 v[36:39], v2, s[40:41] offset:1024 sc1
  global_load_dwordx4 v[40:43], v2, s[40:41] offset:2048 sc1
  global_load_dwordx4 v[44:47], v2, s[40:41] offset:3072 sc1
  v_add_u32 v2, 135168, v9
  global_load_dwordx4 v[48:51], v2, s[40:41] offset:0 sc1
  global_load_dwordx4 v[52:55], v2, s[40:41] offset:1024 sc1
  global_load_dwordx4 v[56:59], v2, s[40:41] offset:2048 sc1
  global_load_dwordx4 v[60:63], v2, s[40:41] offset:3072 sc1
  s_waitcnt vmcnt(0)
L_D2_CK:
  v_max3_u32 v4, v32, v33, v34
  v_max3_u32 v4, v4, v35, v36
  v_max3_u32 v4, v4, v37, v38
  v_max3_u32 v4, v4, v39, v40
  v_max3_u32 v4, v4, v41, v42
  v_max3_u32 v4, v4, v43, v44
  v_max3_u32 v4, v4, v45, v46
  v_max3_u32 v4, v4, v47, v48
  v_max3_u32 v4, v4, v49, v50
  v_max3_u32 v4, v4, v51, v52
  v_max3_u32 v4, v4, v53, v54
  v_max3_u32 v4, v4, v55, v56
  v_max3_u32 v4, v4, v57, v58
  v_max3_u32 v4, v4, v59, v60
  v_max3_u32 v4, v4, v61, v62
  v_max_u32 v4, v4, v63
  v_cmp_eq_u32 vcc, -1, v4
  s_cbranch_vccnz L_D2_RE
L_D2_OK:
L_D2_OK2:
  v_mfma_f32_16x16x32_bf16 v[16:19], v[32:35], v[128:131], 0
  ds_read_b64 v[96:97], v14 offset:0
  ds_read_b64 v[98:99], v14 offset:4096
  v_mfma_f32_16x16x32_bf16 v[20:23], v[32:35], v[160:163], 0
  ds_read_b64 v[100:101], v14 offset:8192
  ds_read_b64 v[102:103], v14 offset:12288
  v_mfma_f32_16x16x32_bf16 v[24:27], v[32:35], v[192:195], 0
  ds_read_b64 v[104:105], v14 offset:16384
  ds_read_b64 v[106:107], v14 offset:20480
  v_mfma_f32_16x16x32_bf16 v[28:31], v[32:35], v[224:227], 0
  ds_read_b64 v[108:109], v14 offset:24576
  ds_read_b64 v[110:111], v14 offset:28672
  v_add_u32 v2, 262144, v9
  global_load_dwordx4 v[32:35], v2, s[40:41] offset:0 sc1
  v_mfma_f32_16x16x32_bf16 v[16:19], v[36:39], v[132:135], v[16:19]
  ds_read_b32 v10, v15 offset:0
  s_add_u32 s50, s56, 0
  v_mfma_f32_16x16x32_bf16 v[20:23], v[36:39], v[164:167], v[20:23]
  s_lshr_b32 s51, s50, 1
  s_lshl_b32 s51, s51, 10
  v_mfma_f32_16x16x32_bf16 v[24:27], v[36:39], v[196:199], v[24:27]
  s_and_b32 s50, s50, 1
  s_lshl_b32 s50, s50, 3
  v_mfma_f32_16x16x32_bf16 v[28:31], v[36:39], v[228:231], v[28:31]
  s_add_u32 s50, s50, s51
  global_load_dwordx4 v[36:39], v2, s[40:41] offset:1024 sc1
  v_mfma_f32_16x16x32_bf16 v[16:19], v[40:43], v[136:139], v[16:19]
  ds_write_b128 v13, v[112:115] offset:32768
  v_mfma_f32_16x16x32_bf16 v[20:23], v[40:43], v[168:171], v[20:23]
  v_mfma_f32_16x16x32_bf16 v[24:27], v[40:43], v[200:203], v[24:27]
  ds_write_b128 v13, v[116:119] offset:33792
  s_waitcnt lgkmcnt(2)
  v_mfma_f32_16x16x32_bf16 v[28:31], v[40:43], v[232:235], v[28:31]
  v_add_f32 v96, v96, v98
  v_add_f32 v97, v97, v99
  global_load_dwordx4 v[40:43], v2, s[40:41] offset:2048 sc1
  v_mfma_f32_16x16x32_bf16 v[16:19], v[44:47], v[140:143], v[16:19]
  ds_write_b128 v13, v[120:123] offset:34816
  v_add_f32 v100, v100, v102
  v_add_f32 v101, v101, v103
  v_mfma_f32_16x16x32_bf16 v[20:23], v[44:47], v[172:175], v[20:23]
  v_add_f32 v104, v104, v106
  v_add_f32 v105, v105, v107
  v_mfma_f32_16x16x32_bf16 v[24:27], v[44:47], v[204:207], v[24:27]
  ds_write_b128 v13, v[124:127] offset:35840
  v_add_f32 v108, v108, v110
  v_add_f32 v109, v109, v111
  v_mfma_f32_16x16x32_bf16 v[28:31], v[44:47], v[236:239], v[28:31]
  v_add_f32 v96, v96, v100
  v_add_f32 v97, v97, v101
  global_load_dwordx4 v[44:47], v2, s[40:41] offset:3072 sc1
  s_waitcnt vmcnt(4)
  v_mfma_f32_16x16x32_bf16 v[16:19], v[48:51], v[144:147], v[16:19]
  v_add_f32 v104, v104, v108
  v_add_f32 v105, v105, v109
  v_max3_u32 v4, v64, v65, v66
  v_mfma_f32_16x16x32_bf16 v[20:23], v[48:51], v[176:179], v[20:23]
  v_add_f32 v96, v96, v104
  v_add_f32 v97, v97, v105
  v_max3_u32 v4, v4, v67, v68
  v_mfma_f32_16x16x32_bf16 v[24:27], v[48:51], v[208:211], v[24:27]
  v_cvt_pk_bf16_f32 v98, v96, v97
  v_max3_u32 v4, v4, v69, v70
  v_mfma_f32_16x16x32_bf16 v[28:31], v[48:51], v[240:243], v[28:31]
  v_lshlrev_b32 v96, 16, v98
  v_max3_u32 v4, v4, v71, v72
  v_add_u32 v2, 266240, v9
  global_load_dwordx4 v[48:51], v2, s[40:41] offset:0 sc1
  v_mfma_f32_16x16x32_bf16 v[16:19], v[52:55], v[148:151], v[16:19]
  v_and_b32 v97, 0xffff0000, v98
  v_max3_u32 v4, v4, v73, v74
  v_mfma_f32_16x16x32_bf16 v[20:23], v[52:55], v[180:183], v[20:23]
  v_add_f32 v96, v96, v8
  v_max3_u32 v4, v4, v75, v76
  v_mfma_f32_16x16x32_bf16 v[24:27], v[52:55], v[212:215], v[24:27]
  v_add_f32 v97, v97, v8
  v_max3_u32 v4, v4, v77, v78
  v_mfma_f32_16x16x32_bf16 v[28:31], v[52:55], v[244:247], v[28:31]
  v_cvt_pk_bf16_f32 v98, v96, v97
  v_max3_u32 v4, v4, v79, v80
  global_load_dwordx4 v[52:55], v2, s[40:41] offset:1024 sc1
  v_mfma_f32_16x16x32_bf16 v[16:19], v[56:59], v[152:155], v[16:19]
  v_lshlrev_b32 v96, 16, v98
  v_max3_u32 v4, v4, v81, v82
  v_mfma_f32_16x16x32_bf16 v[20:23], v[56:59], v[184:187], v[20:23]
  v_and_b32 v97, 0xffff0000, v98
  v_max3_u32 v4, v4, v83, v84
  v_mfma_f32_16x16x32_bf16 v[24:27], v[56:59], v[216:219], v[24:27]
  v_lshlrev_b32 v100, 16, v10
  v_max3_u32 v4, v4, v85, v86
  v_mfma_f32_16x16x32_bf16 v[28:31], v[56:59], v[248:251], v[28:31]
  v_and_b32 v101, 0xffff0000, v10
  v_max3_u32 v4, v4, v87, v88
  global_load_dwordx4 v[56:59], v2, s[40:41] offset:2048 sc1
  v_mfma_f32_16x16x32_bf16 v[16:19], v[60:63], v[156:159], v[16:19]
  v_mul_f32 v96, v96, v100
  v_max3_u32 v4, v4, v89, v90
  v_mfma_f32_16x16x32_bf16 v[20:23], v[60:63], v[188:191], v[20:23]
  v_mul_f32 v97, v97, v101
  v_max3_u32 v4, v4, v91, v92
  v_mfma_f32_16x16x32_bf16 v[24:27], v[60:63], v[220:223], v[24:27]
  v_cvt_pk_bf16_f32 v96, v96, v97
  v_max3_u32 v4, v4, v93, v94
  v_mfma_f32_16x16x32_bf16 v[28:31], v[60:63], v[252:255], v[28:31]
  v_add_u32 v97, s50, v12
  v_max_u32 v4, v4, v95
  global_load_dwordx4 v[60:63], v2, s[40:41] offset:3072 sc1
  v_cmp_eq_u32 vcc, -1, v4
  s_mov_b64 s[64:65], vcc
  global_store_dword v97, v96, s[40:41] sc1
  s_waitcnt lgkmcnt(0)
  s_barrier
  s_cmp_eq_u64 s[64:65], 0
  s_cbranch_scc1 L_D3_OK2
  s_mov_b32 s60, 0
  s_branch L_D3_CK
L_D3_RE:
  s_add_u32 s60, s60, 1
  s_cmp_gt_u32 s60, 200000
  s_cbranch_scc1 L_D3_OK
  v_add_u32 v2, 196608, v9
  global_load_dwordx4 v[64:67], v2, s[40:41] offset:0 sc1
  global_load_dwordx4 v[68:71], v2, s[40:41] offset:1024 sc1
  global_load_dwordx4 v[72:75], v2, s[40:41] offset:2048 sc1
  global_load_dwordx4 v[76:79], v2, s[40:41] offset:3072 sc1
  v_add_u32 v2, 200704, v9
  global_load_dwordx4 v[80:83], v2, s[40:41] offset:0 sc1
  global_load_dwordx4 v[84:87], v2, s[40:41] offset:1024 sc1
  global_load_dwordx4 v[88:91], v2, s[40:41] offset:2048 sc1
  global_load_dwordx4 v[92:95], v2, s[40:41] offset:3072 sc1
  s_waitcnt vmcnt(0)
L_D3_CK:
  v_max3_u32 v4, v64, v65, v66
  v_max3_u32 v4, v4, v67, v68
  v_max3_u32 v4, v4, v69, v70
  v_max3_u32 v4, v4, v71, v72
  v_max3_u32 v4, v4, v73, v74
  v_max3_u32 v4, v4, v75, v76
  v_max3_u32 v4, v4, v77, v78
  v_max3_u32 v4, v4, v79, v80
  v_max3_u32 v4, v4, v81, v82
  v_max3_u32 v4, v4, v83, v84
  v_max3_u32 v4, v4, v85, v86
  v_max3_u32 v4, v4, v87, v88
  v_max3_u32 v4, v4, v89, v90
  v_max3_u32 v4, v4, v91, v92
  v_max3_u32 v4, v4, v93, v94
  v_max_u32 v4, v4, v95
  v_cmp_eq_u32 vcc, -1, v4
  s_cbranch_vccnz L_D3_RE
L_D3_OK:
L_D3_OK2:
  v_mfma_f32_16x16x32_bf16 v[112:115], v[64:67], v[128:131], 0
  ds_read_b64 v[96:97], v14 offset:32768
  ds_read_b64 v[98:99], v14 offset:36864
  v_mfma_f32_16x16x32_bf16 v[116:119], v[64:67], v[160:163], 0
  ds_read_b64 v[100:101], v14 offset:40960
  ds_read_b64 v[102:103], v14 offset:45056
  v_mfma_f32_16x16x32_bf16 v[120:123], v[64:67], v[192:195], 0
  ds_read_b64 v[104:105], v14 offset:49152
  ds_read_b64 v[106:107], v14 offset:53248
  v_mfma_f32_16x16x32_bf16 v[124:127], v[64:67], v[224:227], 0
  ds_read_b64 v[108:109], v14 offset:57344
  ds_read_b64 v[110:111], v14 offset:61440
  v_add_u32 v2, 327680, v9
  global_load_dwordx4 v[64:67], v2, s[40:41] offset:0 sc1
  v_mfma_f32_16x16x32_bf16 v[112:115], v[68:71], v[132:135], v[112:115]
  ds_read_b32 v10, v15 offset:2048
  s_add_u32 s50, s56, 1
  v_mfma_f32_16x16x32_bf16 v[116:119], v[68:71], v[164:167], v[116:119]
  s_lshr_b32 s51, s50, 1
  s_lshl_b32 s51, s51, 10
  v_mfma_f32_16x16x32_bf16 v[120:123], v[68:71], v[196:199], v[120:123]
  s_and_b32 s50, s50, 1
  s_lshl_b32 s50, s50, 3
  v_mfma_f32_16x16x32_bf16 v[124:127], v[68:71], v[228:231], v[124:127]
  s_add_u32 s50, s50, s51
  global_load_dwordx4 v[68:71], v2, s[40:41] offset:1024 sc1
  v_mfma_f32_16x16x32_bf16 v[112:115], v[72:75], v[136:139], v[112:115]
  ds_write_b128 v13, v[16:19] offset:0
  v_mfma_f32_16x16x32_bf16 v[116:119], v[72:75], v[168:171], v[116:119]
  v_mfma_f32_16x16x32_bf16 v[120:123], v[72:75], v[200:203], v[120:123]
  ds_write_b128 v13, v[20:23] offset:1024
  s_waitcnt lgkmcnt(2)
  v_mfma_f32_16x16x32_bf16 v[124:127], v[72:75], v[232:235], v[124:127]
  v_add_f32 v96, v96, v98
  v_add_f32 v97, v97, v99
  global_load_dwordx4 v[72:75], v2, s[40:41] offset:2048 sc1
  v_mfma_f32_16x16x32_bf16 v[112:115], v[76:79], v[140:143], v[112:115]
  ds_write_b128 v13, v[24:27] offset:2048
  v_add_f32 v100, v100, v102
  v_add_f32 v101, v101, v103
  v_mfma_f32_16x16x32_bf16 v[116:119], v[76:79], v[172:175], v[116:119]
  v_add_f32 v104, v104, v106
  v_add_f32 v105, v105, v107
  v_mfma_f32_16x16x32_bf16 v[120:123], v[76:79], v[204:207], v[120:123]
  ds_write_b128 v13, v[28:31] offset:3072
  v_add_f32 v108, v108, v110
  v_add_f32 v109, v109, v111
  v_mfma_f32_16x16x32_bf16 v[124:127], v[76:79], v[236:239], v[124:127]
  v_add_f32 v96, v96, v100
  v_add_f32 v97, v97, v101
  global_load_dwordx4 v[76:79], v2, s[40:41] offset:3072 sc1
  s_waitcnt vmcnt(5)
  v_mfma_f32_16x16x32_bf16 v[112:115], v[80:83], v[144:147], v[112:115]
  v_add_f32 v104, v104, v108
  v_add_f32 v105, v105, v109
  v_max3_u32 v4, v32, v33, v34
  v_mfma_f32_16x16x32_bf16 v[116:119], v[80:83], v[176:179], v[116:119]
  v_add_f32 v96, v96, v104
  v_add_f32 v97, v97, v105
  v_max3_u32 v4, v4, v35, v36
  v_mfma_f32_16x16x32_bf16 v[120:123], v[80:83], v[208:211], v[120:123]
  v_cvt_pk_bf16_f32 v98, v96, v97
  v_max3_u32 v4, v4, v37, v38
  v_mfma_f32_16x16x32_bf16 v[124:127], v[80:83], v[240:243], v[124:127]
  v_lshlrev_b32 v96, 16, v98
  v_max3_u32 v4, v4, v39, v40
  v_add_u32 v2, 331776, v9
  global_load_dwordx4 v[80:83], v2, s[40:41] offset:0 sc1
  v_mfma_f32_16x16x32_bf16 v[112:115], v[84:87], v[148:151], v[112:115]
  v_and_b32 v97, 0xffff0000, v98
  v_max3_u32 v4, v4, v41, v42
  v_mfma_f32_16x16x32_bf16 v[116:119], v[84:87], v[180:183], v[116:119]
  v_add_f32 v96, v96, v8
  v_max3_u32 v4, v4, v43, v44
  v_mfma_f32_16x16x32_bf16 v[120:123], v[84:87], v[212:215], v[120:123]
  v_add_f32 v97, v97, v8
  v_max3_u32 v4, v4, v45, v46
  v_mfma_f32_16x16x32_bf16 v[124:127], v[84:87], v[244:247], v[124:127]
  v_cvt_pk_bf16_f32 v98, v96, v97
  v_max3_u32 v4, v4, v47, v48
  global_load_dwordx4 v[84:87], v2, s[40:41] offset:1024 sc1
  v_mfma_f32_16x16x32_bf16 v[112:115], v[88:91], v[152:155], v[112:115]
  v_lshlrev_b32 v96, 16, v98
  v_max3_u32 v4, v4, v49, v50
  v_mfma_f32_16x16x32_bf16 v[116:119], v[88:91], v[184:187], v[116:119]
  v_and_b32 v97, 0xffff0000, v98
  v_max3_u32 v4, v4, v51, v52
  v_mfma_f32_16x16x32_bf16 v[120:123], v[88:91], v[216:219], v[120:123]
  v_lshlrev_b32 v100, 16, v10
  v_max3_u32 v4, v4, v53, v54
  v_mfma_f32_16x16x32_bf16 v[124:127], v[88:91], v[248:251], v[124:127]
  v_and_b32 v101, 0xffff0000, v10
  v_max3_u32 v4, v4, v55, v56
  global_load_dwordx4 v[88:91], v2, s[40:41] offset:2048 sc1
  v_mfma_f32_16x16x32_bf16 v[112:115], v[92:95], v[156:159], v[112:115]
  v_mul_f32 v96, v96, v100
  v_max3_u32 v4, v4, v57, v58
  v_mfma_f32_16x16x32_bf16 v[116:119], v[92:95], v[188:191], v[116:119]
  v_mul_f32 v97, v97, v101
  v_max3_u32 v4, v4, v59, v60
  v_mfma_f32_16x16x32_bf16 v[120:123], v[92:95], v[220:223], v[120:123]
  v_cvt_pk_bf16_f32 v96, v96, v97
  v_max3_u32 v4, v4, v61, v62
  v_mfma_f32_16x16x32_bf16 v[124:127], v[92:95], v[252:255], v[124:127]
  v_add_u32 v97, s50, v12
  v_max_u32 v4, v4, v63
  global_load_dwordx4 v[92:95], v2, s[40:41] offset:3072 sc1
  v_cmp_eq_u32 vcc, -1, v4
  s_mov_b64 s[64:65], vcc
  global_store_dword v97, v96, s[40:41] sc1
  s_waitcnt lgkmcnt(0)
  s_barrier
  s_cmp_eq_u64 s[64:65], 0
  s_cbranch_scc1 L_D4_OK2
  s_mov_b32 s60, 0
  s_branch L_D4_CK
L_D4_RE:
  s_add_u32 s60, s60, 1
  s_cmp_gt_u32 s60, 200000
  s_cbranch_scc1 L_D4_OK
  v_add_u32 v2, 262144, v9
  global_load_dwordx4 v[32:35], v2, s[40:41] offset:0 sc1
  global_load_dwordx4 v[36:39], v2, s[40:41] offset:1024 sc1
  global_load_dwordx4 v[40:43], v2, s[40:41] offset:2048 sc1
  global_load_dwordx4 v[44:47], v2, s[40:41] offset:3072 sc1
  v_add_u32 v2, 266240, v9
  global_load_dwordx4 v[48:51], v2, s[40:41] offset:0 sc1
  global_load_dwordx4 v[52:55], v2, s[40:41] offset:1024 sc1
  global_load_dwordx4 v[56:59], v2, s[40:41] offset:2048 sc1
  global_load_dwordx4 v[60:63], v2, s[40:41] offset:3072 sc1
  s_waitcnt vmcnt(0)
L_D4_CK:
  v_max3_u32 v4, v32, v33, v34
  v_max3_u32 v4, v4, v35, v36
  v_max3_u32 v4, v4, v37, v38
  v_max3_u32 v4, v4, v39, v40
  v_max3_u32 v4, v4, v41, v42
  v_max3_u32 v4, v4, v43, v44
  v_max3_u32 v4, v4, v45, v46
  v_max3_u32 v4, v4, v47, v48
  v_max3_u32 v4, v4, v49, v50
  v_max3_u32 v4, v4, v51, v52
  v_max3_u32 v4, v4, v53, v54
  v_max3_u32 v4, v4, v55, v56
  v_max3_u32 v4, v4, v57, v58
  v_max3_u32 v4, v4, v59, v60
  v_max3_u32 v4, v4, v61, v62
  v_max_u32 v4, v4, v63
  v_cmp_eq_u32 vcc, -1, v4
  s_cbranch_vccnz L_D4_RE
L_D4_OK:
L_D4_OK2:
  v_mfma_f32_16x16x32_bf16 v[16:19], v[32:35], v[128:131], 0
  ds_read_b64 v[96:97], v14 offset:0
  ds_read_b64 v[98:99], v14 offset:4096
  v_mfma_f32_16x16x32_bf16 v[20:23], v[32:35], v[160:163], 0
  ds_read_b64 v[100:101], v14 offset:8192
  ds_read_b64 v[102:103], v14 offset:12288
  v_mfma_f32_16x16x32_bf16 v[24:27], v[32:35], v[192:195], 0
  ds_read_b64 v[104:105], v14 offset:16384
  ds_read_b64 v[106:107], v14 offset:20480
  v_mfma_f32_16x16x32_bf16 v[28:31], v[32:35], v[224:227], 0
  ds_read_b64 v[108:109], v14 offset:24576
  ds_read_b64 v[110:111], v14 offset:28672
  v_add_u32 v2, 393216, v9
  global_load_dwordx4 v[32:35], v2, s[40:41] offset:0 sc1
  v_mfma_f32_16x16x32_bf16 v[16:19], v[36:39], v[132:135], v[16:19]
  ds_read_b32 v10, v15 offset:4096
  s_add_u32 s50, s56, 2
  v_mfma_f32_16x16x32_bf16 v[20:23], v[36:39], v[164:167], v[20:23]
  s_lshr_b32 s51, s50, 1
  s_lshl_b32 s51, s51, 10
  v_mfma_f32_16x16x32_bf16 v[24:27], v[36:39], v[196:199], v[24:27]
  s_and_b32 s50, s50, 1
  s_lshl_b32 s50, s50, 3
  v_mfma_f32_16x16x32_bf16 v[28:31], v[36:39], v[228:231], v[28:31]
  s_add_u32 s50, s50, s51
  global_load_dwordx4 v[36:39], v2, s[40:41] offset:1024 sc1
  v_mfma_f32_16x16x32_bf16 v[16:19], v[40:43], v[136:139], v[16:19]
  ds_write_b128 v13, v[112:115] offset:32768
  v_mfma_f32_16x16x32_bf16 v[20:23], v[40:43], v[168:171], v[20:23]
  v_mfma_f32_16x16x32_bf16 v[24:27], v[40:43], v[200:203], v[24:27]
  ds_write_b128 v13, v[116:119] offset:33792
  s_waitcnt lgkmcnt(2)
  v_mfma_f32_16x16x32_bf16 v[28:31], v[40:43], v[232:235], v[28:31]
  v_add_f32 v96, v96, v98
  v_add_f32 v97, v97, v99
  global_load_dwordx4 v[40:43], v2, s[40:41] offset:2048 sc1
  v_mfma_f32_16x16x32_bf16 v[16:19], v[44:47], v[140:143], v[16:19]
  ds_write_b128 v13, v[120:123] offset:34816
  v_add_f32 v100, v100, v102
  v_add_f32 v101, v101, v103
  v_mfma_f32_16x16x32_bf16 v[20:23], v[44:47], v[172:175], v[20:23]
  v_add_f32 v104, v104, v106
  v_add_f32 v105, v105, v107
  v_mfma_f32_16x16x32_bf16 v[24:27], v[44:47], v[204:207], v[24:27]
  ds_write_b128 v13, v[124:127] offset:35840
  v_add_f32 v108, v108, v110
  v_add_f32 v109, v109, v111
  v_mfma_f32_16x16x32_bf16 v[28:31], v[44:47], v[236:239], v[28:31]
  v_add_f32 v96, v96, v100
  v_add_f32 v97, v97, v101
  global_load_dwordx4 v[44:47], v2, s[40:41] offset:3072 sc1
  s_waitcnt vmcnt(5)
  v_mfma_f32_16x16x32_bf16 v[16:19], v[48:51], v[144:147], v[16:19]
  v_add_f32 v104, v104, v108
  v_add_f32 v105, v105, v109
  v_max3_u32 v4, v64, v65, v66
  v_mfma_f32_16x16x32_bf16 v[20:23], v[48:51], v[176:179], v[20:23]
  v_add_f32 v96, v96, v104
  v_add_f32 v97, v97, v105
  v_max3_u32 v4, v4, v67, v68
  v_mfma_f32_16x16x32_bf16 v[24:27], v[48:51], v[208:211], v[24:27]
  v_cvt_pk_bf16_f32 v98, v96, v97
  v_max3_u32 v4, v4, v69, v70
  v_mfma_f32_16x16x32_bf16 v[28:31], v[48:51], v[240:243], v[28:31]
  v_lshlrev_b32 v96, 16, v98
  v_max3_u32 v4, v4, v71, v72
  v_add_u32 v2, 397312, v9
  global_load_dwordx4 v[48:51], v2, s[40:41] offset:0 sc1
  v_mfma_f32_16x16x32_bf16 v[16:19], v[52:55], v[148:151], v[16:19]
  v_and_b32 v97, 0xffff0000, v98
  v_max3_u32 v4, v4, v73, v74
  v_mfma_f32_16x16x32_bf16 v[20:23], v[52:55], v[180:183], v[20:23]
  v_add_f32 v96, v96, v8
  v_max3_u32 v4, v4, v75, v76
  v_mfma_f32_16x16x32_bf16 v[24:27], v[52:55], v[212:215], v[24:27]
  v_add_f32 v97, v97, v8
  v_max3_u32 v4, v4, v77, v78
  v_mfma_f32_16x16x32_bf16 v[28:31], v[52:55], v[244:247], v[28:31]
  v_cvt_pk_bf16_f32 v98, v96, v97
  v_max3_u32 v4, v4, v79, v80
  global_load_dwordx4 v[52:55], v2, s[40:41] offset:1024 sc1
  v_mfma_f32_16x16x32_bf16 v[16:19], v[56:59], v[152:155], v[16:19]
  v_lshlrev_b32 v96, 16, v98
  v_max3_u32 v4, v4, v81, v82
  v_mfma_f32_16x16x32_bf16 v[20:23], v[56:59], v[184:187], v[20:23]
  v_and_b32 v97, 0xffff0000, v98
  v_max3_u32 v4, v4, v83, v84
  v_mfma_f32_16x16x32_bf16 v[24:27], v[56:59], v[216:219], v[24:27]
  v_lshlrev_b32 v100, 16, v10
  v_max3_u32 v4, v4, v85, v86
  v_mfma_f32_16x16x32_bf16 v[28:31], v[56:59], v[248:251], v[28:31]
  v_and_b32 v101, 0xffff0000, v10
  v_max3_u32 v4, v4, v87, v88
  global_load_dwordx4 v[56:59], v2, s[40:41] offset:2048 sc1
  v_mfma_f32_16x16x32_bf16 v[16:19], v[60:63], v[156:159], v[16:19]
  v_mul_f32 v96, v96, v100
  v_max3_u32 v4, v4, v89, v90
  v_mfma_f32_16x16x32_bf16 v[20:23], v[60:63], v[188:191], v[20:23]
  v_mul_f32 v97, v97, v101
  v_max3_u32 v4, v4, v91, v92
  v_mfma_f32_16x16x32_bf16 v[24:27], v[60:63], v[220:223], v[24:27]
  v_cvt_pk_bf16_f32 v96, v96, v97
  v_max3_u32 v4, v4, v93, v94
  v_mfma_f32_16x16x32_bf16 v[28:31], v[60:63], v[252:255], v[28:31]
  v_add_u32 v97, s50, v12
  v_max_u32 v4, v4, v95
  global_load_dwordx4 v[60:63], v2, s[40:41] offset:3072 sc1
  v_cmp_eq_u32 vcc, -1, v4
  s_mov_b64 s[64:65], vcc
  global_store_dword v97, v96, s[40:41] sc1
  s_waitcnt lgkmcnt(0)
  s_barrier
  s_cmp_eq_u64 s[64:65], 0
  s_cbranch_scc1 L_D5_OK2
  s_mov_b32 s60, 0
  s_branch L_D5_CK
L_D5_RE:
  s_add_u32 s60, s60, 1
  s_cmp_gt_u32 s60, 200000
  s_cbranch_scc1 L_D5_OK
  v_add_u32 v2, 327680, v9
  global_load_dwordx4 v[64:67], v2, s[40:41] offset:0 sc1
  global_load_dwordx4 v[68:71], v2, s[40:41] offset:1024 sc1
  global_load_dwordx4 v[72:75], v2, s[40:41] offset:2048 sc1
  global_load_dwordx4 v[76:79], v2, s[40:41] offset:3072 sc1
  v_add_u32 v2, 331776, v9
  global_load_dwordx4 v[80:83], v2, s[40:41] offset:0 sc1
  global_load_dwordx4 v[84:87], v2, s[40:41] offset:1024 sc1
  global_load_dwordx4 v[88:91], v2, s[40:41] offset:2048 sc1
  global_load_dwordx4 v[92:95], v2, s[40:41] offset:3072 sc1
  s_waitcnt vmcnt(0)
L_D5_CK:
  v_max3_u32 v4, v64, v65, v66
  v_max3_u32 v4, v4, v67, v68
  v_max3_u32 v4, v4, v69, v70
  v_max3_u32 v4, v4, v71, v72
  v_max3_u32 v4, v4, v73, v74
  v_max3_u32 v4, v4, v75, v76
  v_max3_u32 v4, v4, v77, v78
  v_max3_u32 v4, v4, v79, v80
  v_max3_u32 v4, v4, v81, v82
  v_max3_u32 v4, v4, v83, v84
  v_max3_u32 v4, v4, v85, v86
  v_max3_u32 v4, v4, v87, v88
  v_max3_u32 v4, v4, v89, v90
  v_max3_u32 v4, v4, v91, v92
  v_max3_u32 v4, v4, v93, v94
  v_max_u32 v4, v4, v95
  v_cmp_eq_u32 vcc, -1, v4
  s_cbranch_vccnz L_D5_RE
L_D5_OK:
L_D5_OK2:
  v_mfma_f32_16x16x32_bf16 v[112:115], v[64:67], v[128:131], 0
  ds_read_b64 v[96:97], v14 offset:32768
  ds_read_b64 v[98:99], v14 offset:36864
  v_mfma_f32_16x16x32_bf16 v[116:119], v[64:67], v[160:163], 0
  ds_read_b64 v[100:101], v14 offset:40960
  ds_read_b64 v[102:103], v14 offset:45056
  v_mfma_f32_16x16x32_bf16 v[120:123], v[64:67], v[192:195], 0
  ds_read_b64 v[104:105], v14 offset:49152
  ds_read_b64 v[106:107], v14 offset:53248
  v_mfma_f32_16x16x32_bf16 v[124:127], v[64:67], v[224:227], 0
  ds_read_b64 v[108:109], v14 offset:57344
  ds_read_b64 v[110:111], v14 offset:61440
  v_mfma_f32_16x16x32_bf16 v[112:115], v[68:71], v[132:135], v[112:115]
  ds_read_b32 v10, v15 offset:6144
  s_add_u32 s50, s56, 3
  v_mfma_f32_16x16x32_bf16 v[116:119], v[68:71], v[164:167], v[116:119]
  s_lshr_b32 s51, s50, 1
  s_lshl_b32 s51, s51, 10
  v_mfma_f32_16x16x32_bf16 v[120:123], v[68:71], v[196:199], v[120:123]
  s_and_b32 s50, s50, 1
  s_lshl_b32 s50, s50, 3
  v_mfma_f32_16x16x32_bf16 v[124:127], v[68:71], v[228:231], v[124:127]
  s_add_u32 s50, s50, s51
  v_mfma_f32_16x16x32_bf16 v[112:115], v[72:75], v[136:139], v[112:115]
  ds_write_b128 v13, v[16:19] offset:0
  v_mfma_f32_16x16x32_bf16 v[116:119], v[72:75], v[168:171], v[116:119]
  v_mfma_f32_16x16x32_bf16 v[120:123], v[72:75], v[200:203], v[120:123]
  ds_write_b128 v13, v[20:23] offset:1024
  s_waitcnt lgkmcnt(2)
  v_mfma_f32_16x16x32_bf16 v[124:127], v[72:75], v[232:235], v[124:127]
  v_add_f32 v96, v96, v98
  v_add_f32 v97, v97, v99
  v_mfma_f32_16x16x32_bf16 v[112:115], v[76:79], v[140:143], v[112:115]
  ds_write_b128 v13, v[24:27] offset:2048
  v_add_f32 v100, v100, v102
  v_add_f32 v101, v101, v103
  v_mfma_f32_16x16x32_bf16 v[116:119], v[76:79], v[172:175], v[116:119]
  v_add_f32 v104, v104, v106
  v_add_f32 v105, v105, v107
  v_mfma_f32_16x16x32_bf16 v[120:123], v[76:79], v[204:207], v[120:123]
  ds_write_b128 v13, v[28:31] offset:3072
  v_add_f32 v108, v108, v110
  v_add_f32 v109, v109, v111
  v_mfma_f32_16x16x32_bf16 v[124:127], v[76:79], v[236:239], v[124:127]
  v_add_f32 v96, v96, v100
  v_add_f32 v97, v97, v101
  s_waitcnt vmcnt(1)
  v_mfma_f32_16x16x32_bf16 v[112:115], v[80:83], v[144:147], v[112:115]
  v_add_f32 v104, v104, v108
  v_add_f32 v105, v105, v109
  v_max3_u32 v4, v32, v33, v34
  v_mfma_f32_16x16x32_bf16 v[116:119], v[80:83], v[176:179], v[116:119]
  v_add_f32 v96, v96, v104
  v_add_f32 v97, v97, v105
  v_max3_u32 v4, v4, v35, v36
  v_mfma_f32_16x16x32_bf16 v[120:123], v[80:83], v[208:211], v[120:123]
  v_cvt_pk_bf16_f32 v98, v96, v97
  v_max3_u32 v4, v4, v37, v38
  v_mfma_f32_16x16x32_bf16 v[124:127], v[80:83], v[240:243], v[124:127]
  v_lshlrev_b32 v96, 16, v98
  v_max3_u32 v4, v4, v39, v40
  v_mfma_f32_16x16x32_bf16 v[112:115], v[84:87], v[148:151], v[112:115]
  v_and_b32 v97, 0xffff0000, v98
  v_max3_u32 v4, v4, v41, v42
  v_mfma_f32_16x16x32_bf16 v[116:119], v[84:87], v[180:183], v[116:119]
  v_add_f32 v96, v96, v8
  v_max3_u32 v4, v4, v43, v44
  v_mfma_f32_16x16x32_bf16 v[120:123], v[84:87], v[212:215], v[120:123]
  v_add_f32 v97, v97, v8
  v_max3_u32 v4, v4, v45, v46
  v_mfma_f32_16x16x32_bf16 v[124:127], v[84:87], v[244:247], v[124:127]
  v_cvt_pk_bf16_f32 v98, v96, v97
  v_max3_u32 v4, v4, v47, v48
  v_mfma_f32_16x16x32_bf16 v[112:115], v[88:91], v[152:155], v[112:115]
  v_lshlrev_b32 v96, 16, v98
  v_max3_u32 v4, v4, v49, v50
  v_mfma_f32_16x16x32_bf16 v[116:119], v[88:91], v[184:187], v[116:119]
  v_and_b32 v97, 0xffff0000, v98
  v_max3_u32 v4, v4, v51, v52
  v_mfma_f32_16x16x32_bf16 v[120:123], v[88:91], v[216:219], v[120:123]
  v_lshlrev_b32 v100, 16, v10
  v_max3_u32 v4, v4, v53, v54
  v_mfma_f32_16x16x32_bf16 v[124:127], v[88:91], v[248:251], v[124:127]
  v_and_b32 v101, 0xffff0000, v10
  v_max3_u32 v4, v4, v55, v56
  v_mfma_f32_16x16x32_bf16 v[112:115], v[92:95], v[156:159], v[112:115]
  v_mul_f32 v96, v96, v100
  v_max3_u32 v4, v4, v57, v58
  v_mfma_f32_16x16x32_bf16 v[116:119], v[92:95], v[188:191], v[116:119]
  v_mul_f32 v97, v97, v101
  v_max3_u32 v4, v4, v59, v60
  v_mfma_f32_16x16x32_bf16 v[120:123], v[92:95], v[220:223], v[120:123]
  v_cvt_pk_bf16_f32 v96, v96, v97
  v_max3_u32 v4, v4, v61, v62
  v_mfma_f32_16x16x32_bf16 v[124:127], v[92:95], v[252:255], v[124:127]
  v_add_u32 v97, s50, v12
  v_max_u32 v4, v4, v63
  v_cmp_eq_u32 vcc, -1, v4
  s_mov_b64 s[64:65], vcc
  global_store_dword v97, v96, s[40:41] sc1
  s_waitcnt lgkmcnt(0)
  s_barrier
  s_cmp_eq_u64 s[64:65], 0
  s_cbranch_scc1 L_D6_OK2
  s_mov_b32 s60, 0
  s_branch L_D6_CK
L_D6_RE:
  s_add_u32 s60, s60, 1
  s_cmp_gt_u32 s60, 200000
  s_cbranch_scc1 L_D6_OK
  v_add_u32 v2, 393216, v9
  global_load_dwordx4 v[32:35], v2, s[40:41] offset:0 sc1
  global_load_dwordx4 v[36:39], v2, s[40:41] offset:1024 sc1
  global_load_dwordx4 v[40:43], v2, s[40:41] offset:2048 sc1
  global_load_dwordx4 v[44:47], v2, s[40:41] offset:3072 sc1
  v_add_u32 v2, 397312, v9
  global_load_dwordx4 v[48:51], v2, s[40:41] offset:0 sc1
  global_load_dwordx4 v[52:55], v2, s[40:41] offset:1024 sc1
  global_load_dwordx4 v[56:59], v2, s[40:41] offset:2048 sc1
  global_load_dwordx4 v[60:63], v2, s[40:41] offset:3072 sc1
  s_waitcnt vmcnt(0)
L_D6_CK:
  v_max3_u32 v4, v32, v33, v34
  v_max3_u32 v4, v4, v35, v36
  v_max3_u32 v4, v4, v37, v38
  v_max3_u32 v4, v4, v39, v40
  v_max3_u32 v4, v4, v41, v42
  v_max3_u32 v4, v4, v43, v44
  v_max3_u32 v4, v4, v45, v46
  v_max3_u32 v4, v4, v47, v48
  v_max3_u32 v4, v4, v49, v50
  v_max3_u32 v4, v4, v51, v52
  v_max3_u32 v4, v4, v53, v54
  v_max3_u32 v4, v4, v55, v56
  v_max3_u32 v4, v4, v57, v58
  v_max3_u32 v4, v4, v59, v60
  v_max3_u32 v4, v4, v61, v62
  v_max_u32 v4, v4, v63
  v_cmp_eq_u32 vcc, -1, v4
  s_cbranch_vccnz L_D6_RE
L_D6_OK:
L_D6_OK2:
  v_mfma_f32_16x16x32_bf16 v[16:19], v[32:35], v[128:131], 0
  ds_read_b64 v[96:97], v14 offset:0
  ds_read_b64 v[98:99], v14 offset:4096
  v_mfma_f32_16x16x32_bf16 v[20:23], v[32:35], v[160:163], 0
  ds_read_b64 v[100:101], v14 offset:8192
  ds_read_b64 v[102:103], v14 offset:12288
  v_mfma_f32_16x16x32_bf16 v[24:27], v[32:35], v[192:195], 0
  ds_read_b64 v[104:105], v14 offset:16384
  ds_read_b64 v[106:107], v14 offset:20480
  v_mfma_f32_16x16x32_bf16 v[28:31], v[32:35], v[224:227], 0
  ds_read_b64 v[108:109], v14 offset:24576
  ds_read_b64 v[110:111], v14 offset:28672
  v_mfma_f32_16x16x32_bf16 v[16:19], v[36:39], v[132:135], v[16:19]
  ds_read_b32 v10, v15 offset:8192
  s_add_u32 s50, s56, 4
  v_mfma_f32_16x16x32_bf16 v[20:23], v[36:39], v[164:167], v[20:23]
  s_lshr_b32 s51, s50, 1
  s_lshl_b32 s51, s51, 10
  v_mfma_f32_16x16x32_bf16 v[24:27], v[36:39], v[196:199], v[24:27]
  s_and_b32 s50, s50, 1
  s_lshl_b32 s50, s50, 3
  v_mfma_f32_16x16x32_bf16 v[28:31], v[36:39], v[228:231], v[28:31]
  s_add_u32 s50, s50, s51
  v_mfma_f32_16x16x32_bf16 v[16:19], v[40:43], v[136:139], v[16:19]
  ds_write_b128 v13, v[112:115] offset:32768
  v_mfma_f32_16x16x32_bf16 v[20:23], v[40:43], v[168:171], v[20:23]
  v_mfma_f32_16x16x32_bf16 v[24:27], v[40:43], v[200:203], v[24:27]
  ds_write_b128 v13, v[116:119] offset:33792
  s_waitcnt lgkmcnt(2)
  v_mfma_f32_16x16x32_bf16 v[28:31], v[40:43], v[232:235], v[28:31]
  v_add_f32 v96, v96, v98
  v_add_f32 v97, v97, v99
  v_mfma_f32_16x16x32_bf16 v[16:19], v[44:47], v[140:143], v[16:19]
  ds_write_b128 v13, v[120:123] offset:34816
  v_add_f32 v100, v100, v102
  v_add_f32 v101, v101, v103
  v_mfma_f32_16x16x32_bf16 v[20:23], v[44:47], v[172:175], v[20:23]
  v_add_f32 v104, v104, v106
  v_add_f32 v105, v105, v107
  v_mfma_f32_16x16x32_bf16 v[24:27], v[44:47], v[204:207], v[24:27]
  ds_write_b128 v13, v[124:127] offset:35840
  v_add_f32 v108, v108, v110
  v_add_f32 v109, v109, v111
  v_mfma_f32_16x16x32_bf16 v[28:31], v[44:47], v[236:239], v[28:31]
  v_add_f32 v96, v96, v100
  v_add_f32 v97, v97, v101
  v_mfma_f32_16x16x32_bf16 v[16:19], v[48:51], v[144:147], v[16:19]
  v_add_f32 v104, v104, v108
  v_add_f32 v105, v105, v109
  v_mfma_f32_16x16x32_bf16 v[20:23], v[48:51], v[176:179], v[20:23]
  v_add_f32 v96, v96, v104
  v_add_f32 v97, v97, v105
  v_mfma_f32_16x16x32_bf16 v[24:27], v[48:51], v[208:211], v[24:27]
  v_cvt_pk_bf16_f32 v98, v96, v97
  v_mfma_f32_16x16x32_bf16 v[28:31], v[48:51], v[240:243], v[28:31]
  v_lshlrev_b32 v96, 16, v98
  v_mfma_f32_16x16x32_bf16 v[16:19], v[52:55], v[148:151], v[16:19]
  v_and_b32 v97, 0xffff0000, v98
  v_mfma_f32_16x16x32_bf16 v[20:23], v[52:55], v[180:183], v[20:23]
  v_add_f32 v96, v96, v8
  v_mfma_f32_16x16x32_bf16 v[24:27], v[52:55], v[212:215], v[24:27]
  v_add_f32 v97, v97, v8
  v_mfma_f32_16x16x32_bf16 v[28:31], v[52:55], v[244:247], v[28:31]
  v_cvt_pk_bf16_f32 v98, v96, v97
  v_mfma_f32_16x16x32_bf16 v[16:19], v[56:59], v[152:155], v[16:19]
  v_lshlrev_b32 v96, 16, v98
  v_mfma_f32_16x16x32_bf16 v[20:23], v[56:59], v[184:187], v[20:23]
  v_and_b32 v97, 0xffff0000, v98
  v_mfma_f32_16x16x32_bf16 v[24:27], v[56:59], v[216:219], v[24:27]
  v_lshlrev_b32 v100, 16, v10
  v_mfma_f32_16x16x32_bf16 v[28:31], v[56:59], v[248:251], v[28:31]
  v_and_b32 v101, 0xffff0000, v10
  v_mfma_f32_16x16x32_bf16 v[16:19], v[60:63], v[156:159], v[16:19]
  v_mul_f32 v96, v96, v100
  v_mfma_f32_16x16x32_bf16 v[20:23], v[60:63], v[188:191], v[20:23]
  v_mul_f32 v97, v97, v101
  v_mfma_f32_16x16x32_bf16 v[24:27], v[60:63], v[220:223], v[24:27]
  v_cvt_pk_bf16_f32 v96, v96, v97
  v_mfma_f32_16x16x32_bf16 v[28:31], v[60:63], v[252:255], v[28:31]
  v_add_u32 v97, s50, v12
  global_store_dword v97, v96, s[40:41] sc1
  s_waitcnt lgkmcnt(0)
  s_barrier
  ds_read_b64 v[96:97], v14 offset:32768
  ds_read_b64 v[98:99], v14 offset:36864
  ds_read_b64 v[100:101], v14 offset:40960
  ds_read_b64 v[102:103], v14 offset:45056
  ds_read_b64 v[104:105], v14 offset:49152
  ds_read_b64 v[106:107], v14 offset:53248
  ds_read_b64 v[108:109], v14 offset:57344
  ds_read_b64 v[110:111], v14 offset:61440
  ds_read_b32 v10, v15 offset:10240
  s_add_u32 s50, s56, 5
  s_lshr_b32 s51, s50, 1
  s_lshl_b32 s51, s51, 10
  s_and_b32 s50, s50, 1
  s_lshl_b32 s50, s50, 3
  s_add_u32 s50, s50, s51
  ds_write_b128 v13, v[16:19] offset:0
  ds_write_b128 v13, v[20:23] offset:1024
  ds_write_b128 v13, v[24:27] offset:2048
  ds_write_b128 v13, v[28:31] offset:3072
  s_waitcnt lgkmcnt(4)
  v_add_f32 v96, v96, v98
  v_add_f32 v97, v97, v99
  v_add_f32 v100, v100, v102
  v_add_f32 v101, v101, v103
  v_add_f32 v104, v104, v106
  v_add_f32 v105, v105, v107
  v_add_f32 v108, v108, v110
  v_add_f32 v109, v109, v111
  v_add_f32 v96, v96, v100
  v_add_f32 v97, v97, v101
  v_add_f32 v104, v104, v108
  v_add_f32 v105, v105, v109
  v_add_f32 v96, v96, v104
  v_add_f32 v97, v97, v105
  v_cvt_pk_bf16_f32 v98, v96, v97
  v_lshlrev_b32 v96, 16, v98
  v_and_b32 v97, 0xffff0000, v98
  v_add_f32 v96, v96, v8
  v_add_f32 v97, v97, v8
  v_cvt_pk_bf16_f32 v98, v96, v97
  v_lshlrev_b32 v96, 16, v98
  v_and_b32 v97, 0xffff0000, v98
  v_lshlrev_b32 v100, 16, v10
  v_and_b32 v101, 0xffff0000, v10
  v_mul_f32 v96, v96, v100
  v_mul_f32 v97, v97, v101
  v_cvt_pk_bf16_f32 v96, v96, v97
  v_add_u32 v97, s50, v12
  global_store_dword v97, v96, s[40:41] sc1
  s_waitcnt lgkmcnt(0)
  s_barrier
  ds_read_b64 v[96:97], v14 offset:0
  ds_read_b64 v[98:99], v14 offset:4096
  ds_read_b64 v[100:101], v14 offset:8192
  ds_read_b64 v[102:103], v14 offset:12288
  ds_read_b64 v[104:105], v14 offset:16384
  ds_read_b64 v[106:107], v14 offset:20480
  ds_read_b64 v[108:109], v14 offset:24576
  ds_read_b64 v[110:111], v14 offset:28672
  ds_read_b32 v10, v15 offset:12288
  s_add_u32 s50, s56, 6
  s_lshr_b32 s51, s50, 1
  s_lshl_b32 s51, s51, 10
  s_and_b32 s50, s50, 1
  s_lshl_b32 s50, s50, 3
  s_add_u32 s50, s50, s51
  s_waitcnt lgkmcnt(0)
  v_add_f32 v96, v96, v98
  v_add_f32 v97, v97, v99
  v_add_f32 v100, v100, v102
  v_add_f32 v101, v101, v103
  v_add_f32 v104, v104, v106
  v_add_f32 v105, v105, v107
  v_add_f32 v108, v108, v110
  v_add_f32 v109, v109, v111
  v_add_f32 v96, v96, v100
  v_add_f32 v97, v97, v101
  v_add_f32 v104, v104, v108
  v_add_f32 v105, v105, v109
  v_add_f32 v96, v96, v104
  v_add_f32 v97, v97, v105
  v_cvt_pk_bf16_f32 v98, v96, v97
  v_lshlrev_b32 v96, 16, v98
  v_and_b32 v97, 0xffff0000, v98
  v_add_f32 v96, v96, v8
  v_add_f32 v97, v97, v8
  v_cvt_pk_bf16_f32 v98, v96, v97
  v_lshlrev_b32 v96, 16, v98
  v_and_b32 v97, 0xffff0000, v98
  v_lshlrev_b32 v100, 16, v10
  v_and_b32 v101, 0xffff0000, v10
  v_mul_f32 v96, v96, v100
  v_mul_f32 v97, v97, v101
  v_cvt_pk_bf16_f32 v96, v96, v97
  v_add_u32 v97, s50, v12
  global_store_dword v97, v96, s[40:41] sc1
  s_barrier
  v_lshrrev_b32 v16, 3, v1
  v_and_b32 v17, 7, v1
  v_lshrrev_b32 v18, 1, v17
  v_bfe_u32 v19, v16, 1, 2
  v_xor_b32 v18, v18, v19
  v_lshlrev_b32 v18, 1, v18
  v_and_b32 v19, 1, v17
  v_add_u32 v18, v18, v19
  v_lshlrev_b32 v18, 4, v18
  v_lshl_add_u32 v18, v16, 10, v18
  s_mul_i32 s50, s42, 57344
  s_lshl_b32 s51, s46, 7
  s_add_u32 s50, s50, s51
  s_add_u32 s50, s50, 458752
  v_add_u32 v18, s50, v18
  s_mul_i32 s51, s42, 7168
  s_add_u32 m0, s51, 0
  s_nop 0
  global_load_lds_dwordx4 v18, s[30:31]
  v_add_u32 v18, 8192, v18
  s_add_u32 m0, s51, 1024
  s_nop 0
  global_load_lds_dwordx4 v18, s[30:31]
  v_add_u32 v18, 8192, v18
  s_add_u32 m0, s51, 2048
  s_nop 0
  global_load_lds_dwordx4 v18, s[30:31]
  v_add_u32 v18, 8192, v18
  s_add_u32 m0, s51, 3072
  s_nop 0
  global_load_lds_dwordx4 v18, s[30:31]
  v_add_u32 v18, 8192, v18
  s_add_u32 m0, s51, 4096
  s_nop 0
  global_load_lds_dwordx4 v18, s[30:31]
  v_add_u32 v18, 8192, v18
  s_add_u32 m0, s51, 5120
  s_nop 0
  global_load_lds_dwordx4 v18, s[30:31]
  v_add_u32 v18, 8192, v18
  s_add_u32 m0, s51, 6144
  s_nop 0
  global_load_lds_dwordx4 v18, s[30:31]
  v_and_b32 v2, 7, v0
  v_lshlrev_b32 v2, 5, v2
  v_add_u32 v2, 140288, v2
  ds_read_b128 v[112:115], v2
  ds_read_b128 v[116:119], v2 offset:16
  s_lshl_b32 s50, s45, 2
  s_and_b32 s51, s42, 3
  s_add_u32 s50, s50, s51
  s_mul_i32 s50, s50, 28
  s_lshr_b32 s51, s42, 2
  s_mul_i32 s55, s51, 14
  s_add_u32 s50, s50, s55
  s_lshl_b32 s50, s50, 10
  s_add_u32 s50, s50, 5767168
  v_lshlrev_b32 v3, 4, v1
  v_add_u32 v3, s50, v3
  v_mov_b32 v4, v3
  global_load_dwordx4 v[32:35], v4, s[40:41] offset:0 sc1
  global_load_dwordx4 v[36:39], v4, s[40:41] offset:1024 sc1
  global_load_dwordx4 v[40:43], v4, s[40:41] offset:2048 sc1
  global_load_dwordx4 v[44:47], v4, s[40:41] offset:3072 sc1
  v_add_u32 v4, 4096, v4
  global_load_dwordx4 v[48:51], v4, s[40:41] offset:0 sc1
  global_load_dwordx4 v[52:55], v4, s[40:41] offset:1024 sc1
  global_load_dwordx4 v[56:59], v4, s[40:41] offset:2048 sc1
  global_load_dwordx4 v[60:63], v4, s[40:41] offset:3072 sc1
  v_add_u32 v4, 4096, v4
  global_load_dwordx4 v[64:67], v4, s[40:41] offset:0 sc1
  global_load_dwordx4 v[68:71], v4, s[40:41] offset:1024 sc1
  global_load_dwordx4 v[72:75], v4, s[40:41] offset:2048 sc1
  global_load_dwordx4 v[76:79], v4, s[40:41] offset:3072 sc1
  v_add_u32 v4, 4096, v4
  global_load_dwordx4 v[80:83], v4, s[40:41] offset:0 sc1
  global_load_dwordx4 v[84:87], v4, s[40:41] offset:1024 sc1
  v_lshrrev_b32 v16, 4, v1
  v_bfe_u32 v17, v1, 2, 2
  v_and_b32 v18, 3, v1
  v_lshl_add_u32 v19, v16, 2, v17
  v_lshlrev_b32 v19, 7, v19
  v_lshl_add_u32 v19, v18, 3, v19
  s_mov_b32 s55, 65536
  s_cmp_eq_u32 s51, 0
  s_cselect_b32 s55, s55, 0
  v_add_u32 v19, s55, v19
  v_and_b32 v20, 1, v16
  v_lshlrev_b32 v20, 1, v20
  v_lshrrev_b32 v21, 1, v17
  v_add_u32 v20, v20, v21
  v_xor_b32 v21, 0, v20
  v_lshl_add_u32 v24, v21, 5, v19
  v_xor_b32 v21, 1, v20
  v_lshl_add_u32 v25, v21, 5, v19
  v_xor_b32 v21, 2, v20
  v_lshl_add_u32 v26, v21, 5, v19
  v_xor_b32 v21, 3, v20
  v_lshl_add_u32 v27, v21, 5, v19
  v_and_b32 v2, 15, v1
  s_and_b32 s50, s42, 3
  s_lshl_b32 s50, s50, 4
  v_add_u32 v5, s50, v2
  v_lshlrev_b32 v5, 8, v5
  s_lshl_b32 s50, s51, 14
  s_add_u32 s50, s50, 122880
  v_add_u32 v5, s50, v5
  v_and_b32 v2, 7, v2
  v_add_u32 v6, 0, v16
  v_xor_b32 v6, v6, v2
  v_lshl_add_u32 v28, v6, 4, v5
  v_add_u32 v6, 4, v16
  v_xor_b32 v6, v6, v2
  v_lshl_add_u32 v29, v6, 4, v5
  v_add_u32 v6, 8, v16
  v_xor_b32 v6, v6, v2
  v_lshl_add_u32 v30, v6, 4, v5
  v_add_u32 v6, 12, v16
  v_xor_b32 v6, v6, v2
  v_lshl_add_u32 v31, v6, 4, v5
  v_lshrrev_b32 v22, 3, v0
  v_and_b32 v23, 7, v0
  v_lshlrev_b32 v5, 8, v22
  v_add_u32 v5, 122880, v5
  v_and_b32 v2, 7, v22
  v_lshlrev_b32 v6, 1, v23
  v_xor_b32 v7, v6, v2
  v_xor_b32 v7, 1, v7
  v_xor_b32 v6, v6, v2
  v_lshl_add_u32 v6, v6, 4, v5
  v_lshl_add_u32 v7, v7, 4, v5
  v_lshlrev_b32 v21, 7, v22
  v_lshl_add_u32 v21, v23, 4, v21
  v_add_u32 v21, 155648, v21
  s_lshl_b32 s50, s45, 16
  s_lshl_b32 s55, s46, 7
  s_add_u32 s50, s50, s55
  v_lshlrev_b32 v20, 10, v22
  v_lshl_add_u32 v20, v23, 4, v20
  v_add_u32 v20, s50, v20
  s_waitcnt vmcnt(14)
  s_barrier
  s_mov_b32 s61, 0
  s_mov_b32 s71, 0
  ds_read_b128 v[88:91], v21
L_E_RST:
  ds_read_b64_tr_b16 v[128:129], v24 offset:0
  ds_read_b64_tr_b16 v[130:131], v24 offset:2048
  ds_read_b64_tr_b16 v[132:133], v25 offset:0
  ds_read_b64_tr_b16 v[134:135], v25 offset:2048
  ds_read_b64_tr_b16 v[136:137], v26 offset:0
  ds_read_b64_tr_b16 v[138:139], v26 offset:2048
  ds_read_b64_tr_b16 v[140:141], v27 offset:0
  ds_read_b64_tr_b16 v[142:143], v27 offset:2048
  ds_read_b64_tr_b16 v[144:145], v24 offset:4096
  ds_read_b64_tr_b16 v[146:147], v24 offset:6144
  ds_read_b64_tr_b16 v[148:149], v25 offset:4096
  ds_read_b64_tr_b16 v[150:151], v25 offset:6144
  ds_read_b64_tr_b16 v[152:153], v26 offset:4096
  ds_read_b64_tr_b16 v[154:155], v26 offset:6144
  ds_read_b64_tr_b16 v[156:157], v27 offset:4096
  ds_read_b64_tr_b16 v[158:159], v27 offset:6144
  ds_read_b64_tr_b16 v[160:161], v24 offset:8192
  ds_read_b64_tr_b16 v[162:163], v24 offset:10240
  ds_read_b64_tr_b16 v[164:165], v25 offset:8192
  ds_read_b64_tr_b16 v[166:167], v25 offset:10240
  ds_read_b64_tr_b16 v[168:169], v26 offset:8192
  ds_read_b64_tr_b16 v[170:171], v26 offset:10240
  ds_read_b64_tr_b16 v[172:173], v27 offset:8192
  ds_read_b64_tr_b16 v[174:175], v27 offset:10240
  ds_read_b64_tr_b16 v[176:177], v24 offset:12288
  ds_read_b64_tr_b16 v[178:179], v24 offset:14336
  ds_read_b64_tr_b16 v[180:181], v25 offset:12288
  ds_read_b64_tr_b16 v[182:183], v25 offset:14336
  ds_read_b64_tr_b16 v[184:185], v26 offset:12288
  ds_read_b64_tr_b16 v[186:187], v26 offset:14336
  ds_read_b64_tr_b16 v[188:189], v27 offset:12288
  ds_read_b64_tr_b16 v[190:191], v27 offset:14336
  ds_read_b64_tr_b16 v[192:193], v24 offset:16384
  ds_read_b64_tr_b16 v[194:195], v24 offset:18432
  ds_read_b64_tr_b16 v[196:197], v25 offset:16384
  ds_read_b64_tr_b16 v[198:199], v25 offset:18432
  ds_read_b64_tr_b16 v[200:201], v26 offset:16384
  ds_read_b64_tr_b16 v[202:203], v26 offset:18432
  ds_read_b64_tr_b16 v[204:205], v27 offset:16384
  ds_read_b64_tr_b16 v[206:207], v27 offset:18432
  ds_read_b64_tr_b16 v[208:209], v24 offset:20480
  ds_read_b64_tr_b16 v[210:211], v24 offset:22528
  ds_read_b64_tr_b16 v[212:213], v25 offset:20480
  ds_read_b64_tr_b16 v[214:215], v25 offset:22528
  ds_read_b64_tr_b16 v[216:217], v26 offset:20480
  ds_read_b64_tr_b16 v[218:219], v26 offset:22528
  ds_read_b64_tr_b16 v[220:221], v27 offset:20480
  ds_read_b64_tr_b16 v[222:223], v27 offset:22528
  ds_read_b64_tr_b16 v[224:225], v24 offset:24576
  ds_read_b64_tr_b16 v[226:227], v24 offset:26624
  ds_read_b64_tr_b16 v[228:229], v25 offset:24576
  ds_read_b64_tr_b16 v[230:231], v25 offset:26624
  ds_read_b64_tr_b16 v[232:233], v26 offset:24576
  ds_read_b64_tr_b16 v[234:235], v26 offset:26624
  ds_read_b64_tr_b16 v[236:237], v27 offset:24576
  ds_read_b64_tr_b16 v[238:239], v27 offset:26624
  ds_read_b64_tr_b16 v[240:241], v24 offset:28672
  ds_read_b64_tr_b16 v[242:243], v24 offset:30720
  ds_read_b64_tr_b16 v[244:245], v25 offset:28672
  ds_read_b64_tr_b16 v[246:247], v25 offset:30720
  ds_read_b64_tr_b16 v[248:249], v26 offset:28672
  ds_read_b64_tr_b16 v[250:251], v26 offset:30720
  ds_read_b64_tr_b16 v[252:253], v27 offset:28672
  ds_read_b64_tr_b16 v[254:255], v27 offset:30720
  s_cmp_eq_u32 s61, 1
  s_cbranch_scc1 L_E_G0
  s_waitcnt vmcnt(10)
  v_max3_u32 v2, v32, v33, v34
  v_max3_u32 v2, v2, v35, v36
  v_max3_u32 v2, v2, v37, v38
  v_max3_u32 v2, v2, v39, v40
  v_max3_u32 v2, v2, v41, v42
  v_max3_u32 v2, v2, v43, v44
  v_max3_u32 v2, v2, v45, v46
  v_max_u32 v2, v2, v47
  v_cmp_eq_u32 vcc, -1, v2
  s_cbranch_vccnz L_E_SLOW
L_E_G0:
  s_waitcnt lgkmcnt(0)
  v_mfma_f32_16x16x32_bf16 v[96:99], v[128:131], v[32:35], 0
  v_mfma_f32_16x16x32_bf16 v[100:103], v[132:135], v[32:35], 0
  v_mfma_f32_16x16x32_bf16 v[104:107], v[136:139], v[32:35], 0
  v_mfma_f32_16x16x32_bf16 v[108:111], v[140:143], v[32:35], 0
  ds_read_b64_tr_b16 v[128:129], v24 offset:32768
  ds_read_b64_tr_b16 v[130:131], v24 offset:34816
  ds_read_b64_tr_b16 v[132:133], v25 offset:32768
  ds_read_b64_tr_b16 v[134:135], v25 offset:34816
  ds_read_b64_tr_b16 v[136:137], v26 offset:32768
  ds_read_b64_tr_b16 v[138:139], v26 offset:34816
  ds_read_b64_tr_b16 v[140:141], v27 offset:32768
  ds_read_b64_tr_b16 v[142:143], v27 offset:34816
  v_mfma_f32_16x16x32_bf16 v[96:99], v[144:147], v[36:39], v[96:99]
  v_mfma_f32_16x16x32_bf16 v[100:103], v[148:151], v[36:39], v[100:103]
  v_mfma_f32_16x16x32_bf16 v[104:107], v[152:155], v[36:39], v[104:107]
  v_mfma_f32_16x16x32_bf16 v[108:111], v[156:159], v[36:39], v[108:111]
  ds_read_b64_tr_b16 v[144:145], v24 offset:36864
  ds_read_b64_tr_b16 v[146:147], v24 offset:38912
  ds_read_b64_tr_b16 v[148:149], v25 offset:36864
  ds_read_b64_tr_b16 v[150:151], v25 offset:38912
  ds_read_b64_tr_b16 v[152:153], v26 offset:36864
  ds_read_b64_tr_b16 v[154:155], v26 offset:38912
  ds_read_b64_tr_b16 v[156:157], v27 offset:36864
  ds_read_b64_tr_b16 v[158:159], v27 offset:38912
  v_mfma_f32_16x16x32_bf16 v[96:99], v[160:163], v[40:43], v[96:99]
  v_mfma_f32_16x16x32_bf16 v[100:103], v[164:167], v[40:43], v[100:103]
  v_mfma_f32_16x16x32_bf16 v[104:107], v[168:171], v[40:43], v[104:107]
  v_mfma_f32_16x16x32_bf16 v[108:111], v[172:175], v[40:43], v[108:111]
  ds_read_b64_tr_b16 v[160:161], v24 offset:40960
  ds_read_b64_tr_b16 v[162:163], v24 offset:43008
  ds_read_b64_tr_b16 v[164:165], v25 offset:40960
  ds_read_b64_tr_b16 v[166:167], v25 offset:43008
  ds_read_b64_tr_b16 v[168:169], v26 offset:40960
  ds_read_b64_tr_b16 v[170:171], v26 offset:43008
  ds_read_b64_tr_b16 v[172:173], v27 offset:40960
  ds_read_b64_tr_b16 v[174:175], v27 offset:43008
  v_mfma_f32_16x16x32_bf16 v[96:99], v[176:179], v[44:47], v[96:99]
  v_mfma_f32_16x16x32_bf16 v[100:103], v[180:183], v[44:47], v[100:103]
  v_mfma_f32_16x16x32_bf16 v[104:107], v[184:187], v[44:47], v[104:107]
  v_mfma_f32_16x16x32_bf16 v[108:111], v[188:191], v[44:47], v[108:111]
  ds_read_b64_tr_b16 v[176:177], v24 offset:45056
  ds_read_b64_tr_b16 v[178:179], v24 offset:47104
  ds_read_b64_tr_b16 v[180:181], v25 offset:45056
  ds_read_b64_tr_b16 v[182:183], v25 offset:47104
  ds_read_b64_tr_b16 v[184:185], v26 offset:45056
  ds_read_b64_tr_b16 v[186:187], v26 offset:47104
  ds_read_b64_tr_b16 v[188:189], v27 offset:45056
  ds_read_b64_tr_b16 v[190:191], v27 offset:47104
  s_cmp_eq_u32 s61, 1
  s_cbranch_scc1 L_E_G1
  s_waitcnt vmcnt(5)
  v_max3_u32 v2, v48, v49, v50
  v_max3_u32 v2, v2, v51, v52
  v_max3_u32 v2, v2, v53, v54
  v_max3_u32 v2, v2, v55, v56
  v_max3_u32 v2, v2, v57, v58
  v_max3_u32 v2, v2, v59, v60
  v_max3_u32 v2, v2, v61, v62
  v_max3_u32 v2, v2, v63, v64
  v_max3_u32 v2, v2, v65, v66
  v_max_u32 v2, v2, v67
  v_cmp_eq_u32 vcc, -1, v2
  s_cbranch_vccnz L_E_SLOW
L_E_G1:
  v_mfma_f32_16x16x32_bf16 v[96:99], v[192:195], v[48:51], v[96:99]
  v_mfma_f32_16x16x32_bf16 v[100:103], v[196:199], v[48:51], v[100:103]
  v_mfma_f32_16x16x32_bf16 v[104:107], v[200:203], v[48:51], v[104:107]
  v_mfma_f32_16x16x32_bf16 v[108:111], v[204:207], v[48:51], v[108:111]
  ds_read_b64_tr_b16 v[192:193], v24 offset:49152
  ds_read_b64_tr_b16 v[194:195], v24 offset:51200
  ds_read_b64_tr_b16 v[196:197], v25 offset:49152
  ds_read_b64_tr_b16 v[198:199], v25 offset:51200
  ds_read_b64_tr_b16 v[200:201], v26 offset:49152
  ds_read_b64_tr_b16 v[202:203], v26 offset:51200
  ds_read_b64_tr_b16 v[204:205], v27 offset:49152
  ds_read_b64_tr_b16 v[206:207], v27 offset:51200
  v_mfma_f32_16x16x32_bf16 v[96:99], v[208:211], v[52:55], v[96:99]
  v_mfma_f32_16x16x32_bf16 v[100:103], v[212:215], v[52:55], v[100:103]
  v_mfma_f32_16x16x32_bf16 v[104:107], v[216:219], v[52:55], v[104:107]
  v_mfma_f32_16x16x32_bf16 v[108:111], v[220:223], v[52:55], v[108:111]
  ds_read_b64_tr_b16 v[208:209], v24 offset:53248
  ds_read_b64_tr_b16 v[210:211], v24 offset:55296
  ds_read_b64_tr_b16 v[212:213], v25 offset:53248
  ds_read_b64_tr_b16 v[214:215], v25 offset:55296
  ds_read_b64_tr_b16 v[216:217], v26 offset:53248
  ds_read_b64_tr_b16 v[218:219], v26 offset:55296
  ds_read_b64_tr_b16 v[220:221], v27 offset:53248
  ds_read_b64_tr_b16 v[222:223], v27 offset:55296
  v_mfma_f32_16x16x32_bf16 v[96:99], v[224:227], v[56:59], v[96:99]
  v_mfma_f32_16x16x32_bf16 v[100:103], v[228:231], v[56:59], v[100:103]
  v_mfma_f32_16x16x32_bf16 v[104:107], v[232:235], v[56:59], v[104:107]
  v_mfma_f32_16x16x32_bf16 v[108:111], v[236:239], v[56:59], v[108:111]
  v_mfma_f32_16x16x32_bf16 v[96:99], v[240:243], v[60:63], v[96:99]
  v_mfma_f32_16x16x32_bf16 v[100:103], v[244:247], v[60:63], v[100:103]
  v_mfma_f32_16x16x32_bf16 v[104:107], v[248:251], v[60:63], v[104:107]
  v_mfma_f32_16x16x32_bf16 v[108:111], v[252:255], v[60:63], v[108:111]
  s_waitcnt lgkmcnt(0)
  v_mfma_f32_16x16x32_bf16 v[96:99], v[128:131], v[64:67], v[96:99]
  v_mfma_f32_16x16x32_bf16 v[100:103], v[132:135], v[64:67], v[100:103]
  v_mfma_f32_16x16x32_bf16 v[104:107], v[136:139], v[64:67], v[104:107]
  v_mfma_f32_16x16x32_bf16 v[108:111], v[140:143], v[64:67], v[108:111]
  s_cmp_eq_u32 s61, 1
  s_cbranch_scc1 L_E_G2
  s_waitcnt vmcnt(0)
  v_max3_u32 v2, v68, v69, v70
  v_max3_u32 v2, v2, v71, v72
  v_max3_u32 v2, v2, v73, v74
  v_max3_u32 v2, v2, v75, v76
  v_max3_u32 v2, v2, v77, v78
  v_max3_u32 v2, v2, v79, v80
  v_max3_u32 v2, v2, v81, v82
  v_max3_u32 v2, v2, v83, v84
  v_max3_u32 v2, v2, v85, v86
  v_max_u32 v2, v2, v87
  v_cmp_eq_u32 vcc, -1, v2
  s_cbranch_vccnz L_E_SLOW
L_E_G2:
  v_mfma_f32_16x16x32_bf16 v[96:99], v[144:147], v[68:71], v[96:99]
  v_mfma_f32_16x16x32_bf16 v[100:103], v[148:151], v[68:71], v[100:103]
  v_mfma_f32_16x16x32_bf16 v[104:107], v[152:155], v[68:71], v[104:107]
  v_mfma_f32_16x16x32_bf16 v[108:111], v[156:159], v[68:71], v[108:111]
  v_mfma_f32_16x16x32_bf16 v[96:99], v[160:163], v[72:75], v[96:99]
  v_mfma_f32_16x16x32_bf16 v[100:103], v[164:167], v[72:75], v[100:103]
  v_mfma_f32_16x16x32_bf16 v[104:107], v[168:171], v[72:75], v[104:107]
  v_mfma_f32_16x16x32_bf16 v[108:111], v[172:175], v[72:75], v[108:111]
  v_mfma_f32_16x16x32_bf16 v[96:99], v[176:179], v[76:79], v[96:99]
  v_mfma_f32_16x16x32_bf16 v[100:103], v[180:183], v[76:79], v[100:103]
  v_mfma_f32_16x16x32_bf16 v[104:107], v[184:187], v[76:79], v[104:107]
  v_mfma_f32_16x16x32_bf16 v[108:111], v[188:191], v[76:79], v[108:111]
  v_mfma_f32_16x16x32_bf16 v[96:99], v[192:195], v[80:83], v[96:99]
  v_mfma_f32_16x16x32_bf16 v[100:103], v[196:199], v[80:83], v[100:103]
  v_mfma_f32_16x16x32_bf16 v[104:107], v[200:203], v[80:83], v[104:107]
  v_mfma_f32_16x16x32_bf16 v[108:111], v[204:207], v[80:83], v[108:111]
  v_mfma_f32_16x16x32_bf16 v[96:99], v[208:211], v[84:87], v[96:99]
  v_mfma_f32_16x16x32_bf16 v[100:103], v[212:215], v[84:87], v[100:103]
  v_mfma_f32_16x16x32_bf16 v[104:107], v[216:219], v[84:87], v[104:107]
  v_mfma_f32_16x16x32_bf16 v[108:111], v[220:223], v[84:87], v[108:111]
  s_nop 7
  s_branch L_E_CONT
L_E_SLOW:
  s_mov_b32 s60, 0
L_PP:
  s_add_u32 s60, s60, 1
  s_cmp_gt_u32 s60, 200000
  s_cbranch_scc1 L_PP_X
  v_mov_b32 v4, v3
  global_load_dwordx4 v[32:35], v4, s[40:41] offset:0 sc1
  global_load_dwordx4 v[36:39], v4, s[40:41] offset:1024 sc1
  global_load_dwordx4 v[40:43], v4, s[40:41] offset:2048 sc1
  global_load_dwordx4 v[44:47], v4, s[40:41] offset:3072 sc1
  v_add_u32 v4, 4096, v4
  global_load_dwordx4 v[48:51], v4, s[40:41] offset:0 sc1
  global_load_dwordx4 v[52:55], v4, s[40:41] offset:1024 sc1
  global_load_dwordx4 v[56:59], v4, s[40:41] offset:2048 sc1
  global_load_dwordx4 v[60:63], v4, s[40:41] offset:3072 sc1
  v_add_u32 v4, 4096, v4
  global_load_dwordx4 v[64:67], v4, s[40:41] offset:0 sc1
  global_load_dwordx4 v[68:71], v4, s[40:41] offset:1024 sc1
  global_load_dwordx4 v[72:75], v4, s[40:41] offset:2048 sc1
  global_load_dwordx4 v[76:79], v4, s[40:41] offset:3072 sc1
  v_add_u32 v4, 4096, v4
  global_load_dwordx4 v[80:83], v4, s[40:41] offset:0 sc1
  global_load_dwordx4 v[84:87], v4, s[40:41] offset:1024 sc1
  s_waitcnt vmcnt(0)
  v_max3_u32 v2, v32, v33, v34
  v_max3_u32 v2, v2, v35, v36
  v_max3_u32 v2, v2, v37, v38
  v_max3_u32 v2, v2, v39, v40
  v_max3_u32 v2, v2, v41, v42
  v_max3_u32 v2, v2, v43, v44
  v_max3_u32 v2, v2, v45, v46
  v_max3_u32 v2, v2, v47, v48
  v_max3_u32 v2, v2, v49, v50
  v_max3_u32 v2, v2, v51, v52
  v_max3_u32 v2, v2, v53, v54
  v_max3_u32 v2, v2, v55, v56
  v_max3_u32 v2, v2, v57, v58
  v_max3_u32 v2, v2, v59, v60
  v_max3_u32 v2, v2, v61, v62
  v_max3_u32 v2, v2, v63, v64
  v_max3_u32 v2, v2, v65, v66
  v_max3_u32 v2, v2, v67, v68
  v_max3_u32 v2, v2, v69, v70
  v_max3_u32 v2, v2, v71, v72
  v_max3_u32 v2, v2, v73, v74
  v_max3_u32 v2, v2, v75, v76
  v_max3_u32 v2, v2, v77, v78
  v_max3_u32 v2, v2, v79, v80
  v_max3_u32 v2, v2, v81, v82
  v_max3_u32 v2, v2, v83, v84
  v_max3_u32 v2, v2, v85, v86
  v_max_u32 v2, v2, v87
  v_cmp_eq_u32 vcc, -1, v2
  s_cbranch_vccnz L_PP
L_PP_X:
  s_mov_b32 s71, s60
  s_mov_b32 s61, 1
  s_waitcnt lgkmcnt(0)
  s_nop 7
  s_nop 7
  s_branch L_E_RST
L_E_CONT:
  ds_write_b128 v28, v[96:99]
  ds_write_b128 v29, v[100:103]
  ds_write_b128 v30, v[104:107]
  ds_write_b128 v31, v[108:111]
  v_lshlrev_b32 v120, 16, v88
  v_and_b32 v121, 0xffff0000, v88
  v_lshlrev_b32 v122, 16, v89
  v_and_b32 v123, 0xffff0000, v89
  v_lshlrev_b32 v124, 16, v90
  v_and_b32 v125, 0xffff0000, v90
  v_lshlrev_b32 v126, 16, v91
  v_and_b32 v127, 0xffff0000, v91
  s_waitcnt lgkmcnt(0)
  s_barrier
  ds_read_b128 v[32:35], v6
  ds_read_b128 v[36:39], v7
  ds_read_b128 v[40:43], v6 offset:16384
  ds_read_b128 v[44:47], v7 offset:16384
  s_waitcnt lgkmcnt(0)
  v_add_f32 v32, v32, v40
  v_add_f32 v33, v33, v41
  v_add_f32 v34, v34, v42
  v_add_f32 v35, v35, v43
  v_add_f32 v36, v36, v44
  v_add_f32 v37, v37, v45
  v_add_f32 v38, v38, v46
  v_add_f32 v39, v39, v47
  v_cvt_pk_bf16_f32 v48, v32, v33
  v_cvt_pk_bf16_f32 v49, v34, v35
  v_cvt_pk_bf16_f32 v50, v36, v37
  v_cvt_pk_bf16_f32 v51, v38, v39
  v_lshlrev_b32 v32, 16, v48
  v_and_b32 v33, 0xffff0000, v48
  v_lshlrev_b32 v34, 16, v49
  v_and_b32 v35, 0xffff0000, v49
  v_lshlrev_b32 v36, 16, v50
  v_and_b32 v37, 0xffff0000, v50
  v_lshlrev_b32 v38, 16, v51
  v_and_b32 v39, 0xffff0000, v51
  v_mul_f32 v32, v32, v112
  v_mul_f32 v33, v33, v113
  v_mul_f32 v34, v34, v114
  v_mul_f32 v35, v35, v115
  v_mul_f32 v36, v36, v116
  v_mul_f32 v37, v37, v117
  v_mul_f32 v38, v38, v118
  v_mul_f32 v39, v39, v119
  v_cvt_pk_bf16_f32 v48, v32, v33
  v_cvt_pk_bf16_f32 v49, v34, v35
  v_cvt_pk_bf16_f32 v50, v36, v37
  v_cvt_pk_bf16_f32 v51, v38, v39
  v_lshlrev_b32 v32, 16, v48
  v_and_b32 v33, 0xffff0000, v48
  v_lshlrev_b32 v34, 16, v49
  v_and_b32 v35, 0xffff0000, v49
  v_lshlrev_b32 v36, 16, v50
  v_and_b32 v37, 0xffff0000, v50
  v_lshlrev_b32 v38, 16, v51
  v_and_b32 v39, 0xffff0000, v51
  v_add_f32 v32, v32, v120
  v_add_f32 v33, v33, v121
  v_add_f32 v34, v34, v122
  v_add_f32 v35, v35, v123
  v_add_f32 v36, v36, v124
  v_add_f32 v37, v37, v125
  v_add_f32 v38, v38, v126
  v_add_f32 v39, v39, v127
  v_cvt_pk_bf16_f32 v40, v32, v33
  v_cvt_pk_bf16_f32 v41, v34, v35
  v_cvt_pk_bf16_f32 v42, v36, v37
  v_cvt_pk_bf16_f32 v43, v38, v39
  global_store_dwordx4 v20, v[40:43], s[36:37]
  s_cmp_eq_u32 s2, 0
  s_cbranch_scc0 L_END
  s_cmp_eq_u32 s42, 0
  s_cbranch_scc0 L_END
  v_mov_b32 v2, 20447232
  v_mov_b32 v3, s43
  s_mov_b64 exec, 1
  global_store_dword v2, v3, s[40:41] sc1
L_END:
  s_endpgm
L_CODE_END:
.section .rodata,"a"
.p2align 6
.amdhsa_kernel adaLN_cond__ssm_conv_s4__mixer_gmlp__prompt_kernel
  .amdhsa_next_free_vgpr 256
  .amdhsa_next_free_sgpr 102
  .amdhsa_accum_offset 256
  .amdhsa_group_segment_fixed_size 0
  .amdhsa_kernarg_size 152
  .amdhsa_user_sgpr_count 2
  .amdhsa_user_sgpr_kernarg_segment_ptr 1
  .amdhsa_system_sgpr_workgroup_id_x 1
.end_amdhsa_kernel
```
